```python
import torch

def _softmax(x, axis=-1):
    return torch.softmax(x, dim=axis)
def _gelu(x):
    return torch.nn.functional.gelu(x, approximate="tanh")
def _silu(x):
    return torch.nn.functional.silu(x)
def _sigmoid(x):
    return torch.sigmoid(x)
def _layernorm(x, axis=-1, eps=1e-5):
    m = x.mean(dim=axis, keepdim=True)
    v = x.var(dim=axis, keepdim=True, unbiased=False)
    return (x - m) / torch.sqrt(v + eps)
def _scatter_add(tgt, idx, src, axis=0):
    return tgt.clone().index_add_(axis, idx, src)
def _segment_sum(src, seg, n):
    out = torch.zeros((n,) + src.shape[1:], dtype=src.dtype)
    return out.index_add_(0, seg, src)
def _pad(x, pw):
    flat = tuple(v for pair in reversed(pw) for v in pair)
    return torch.nn.functional.pad(x, flat)

kernel_name = 'sequential_preLN__ssm_conv_s4__dense_activation_squared_relu__prompt'

def setup_inputs():

    _w = (lambda a: (lambda t: t.to(torch.bfloat16) if t.is_floating_point() else t)(torch.as_tensor(a)))
    def _A_setup():
        B, L, D, N = 1, 2048, 512, 128
        A_re = -(lambda _x: torch.exp(torch.as_tensor(_x)))((lambda *s: torch.randn(*s, dtype=torch.bfloat16) * 3.2)(D, N))
        A_im = torch.pi * (lambda *s: torch.randn(*s, dtype=torch.bfloat16) * 0.05)(D, N)
        B_re = (lambda *s: torch.randn(*s, dtype=torch.bfloat16) * 0.1)(D, N)
        B_im = (lambda *s: torch.randn(*s, dtype=torch.bfloat16) * 0.1)(D, N)
        C_re = (lambda *s: torch.randn(*s, dtype=torch.bfloat16) * 0.1)(D, N)
        C_im = (lambda *s: torch.randn(*s, dtype=torch.bfloat16) * 0.1)(D, N)
        log_dt = (lambda *s: torch.randn(*s, dtype=torch.bfloat16) * 0.05)(D) * 0.5 - 4.0
        Dskip = (lambda *s: torch.randn(*s, dtype=torch.bfloat16) * 0.05)(D)
        return {
            "u": _w((lambda *s: torch.randn(*s, dtype=torch.bfloat16) * 0.05)(B, L, D)),
            "A_re": _w(A_re),
            "A_im": _w(A_im),
            "B_re": _w(B_re),
            "B_im": _w(B_im),
            "C_re": _w(C_re),
            "C_im": _w(C_im),
            "log_dt": _w(log_dt),
            "Dskip": _w(Dskip),
        }
    _A_in = _A_setup()

    def _B_setup():
        B, S, D, F = 1, 2048, 512, 1792
        return {
            "x": _w((lambda *s: torch.randn(*s, dtype=torch.bfloat16) * 0.05)(B, S, D)),
            "w1": _w((lambda *s: torch.randn(*s, dtype=torch.bfloat16) * 0.05)(D, F)),
            "b1": _w((lambda *s: torch.randn(*s, dtype=torch.bfloat16) * 0.2)(F)),
            "w2": _w((lambda *s: torch.randn(*s, dtype=torch.bfloat16) * 0.05)(F, D)),
            "b2": _w((lambda *s: torch.randn(*s, dtype=torch.bfloat16) * 1.6)(D)),
        }
    _B_in = _B_setup()

    return {
        "A_u": _A_in["u"],
        "A_A_re": _A_in["A_re"],
        "A_A_im": _A_in["A_im"],
        "A_B_re": _A_in["B_re"],
        "A_B_im": _A_in["B_im"],
        "A_C_re": _A_in["C_re"],
        "A_C_im": _A_in["C_im"],
        "A_log_dt": _A_in["log_dt"],
        "A_Dskip": _A_in["Dskip"],
        "B_x": _B_in["x"],
        "B_w1": _B_in["w1"],
        "B_b1": _B_in["b1"],
        "B_w2": _B_in["w2"],
        "B_b2": _B_in["b2"],
    }

def reference(A_u, A_A_re, A_A_im, A_B_re, A_B_im, A_C_re, A_C_im, A_log_dt, A_Dskip, B_x, B_w1, B_b1, B_w2, B_b2):
    def _A_ref(u, A_re, A_im, B_re, B_im, C_re, C_im, log_dt, Dskip):
        Bsz, L, D = u.shape
        dt = torch.exp(log_dt)[:, None]
        A = A_re + 1j * A_im
        Bc = B_re + 1j * B_im
        Cc = C_re + 1j * C_im
        logdA = dt * A
        dB = dt * Bc
        l = (lambda x, dt: x.to(dt))(torch.arange(L), A_re.dtype)
        P = torch.exp(logdA[:, :, None] * l[None, None, :])
        K = torch.einsum("dn,dnl,dn->dl", Cc, P, dB).real
        L2 = 2 * L
        Kp = _pad(K, ((0, 0), (0, L)))
        up = (lambda x, *d: x.permute(*d))(u, 0, 2, 1)
        up = _pad(up, ((0, 0), (0, 0), (0, L)))
        Kf = (lambda x, axes=(-2,-1): torch.fft.rfft2(x.float(), dim=axes))(Kp[:, None, :], axes=(-2, -1))
        Uf = (lambda x, axes=(-2,-1): torch.fft.rfft2(x.float(), dim=axes))(up[:, :, None, :], axes=(-2, -1))
        Yf = Uf * Kf[None, :, :, :]
        y = (lambda x, s, axes=(-2,-1): torch.fft.irfft2(x, s=s, dim=axes).to(torch.bfloat16))(Yf, (1, L2), axes=(-2, -1))[:, :, 0, :L]
        y = (lambda x, *d: x.permute(*d))(y, 0, 2, 1) + u * Dskip[None, None, :]
        return y

    def _B_ref(x, w1, b1, w2, b2):
        h = torch.einsum("bsd,df->bsf", x, w1) + b1
        zero = torch.zeros_like(h)
        r = torch.where(h > zero, h, zero)
        h = r * r
        out = torch.einsum("bsf,fd->bsd", h, w2) + b2
        return out

    x = A_u
    h = x + _A_ref(_layernorm(x, axis=-1), A_A_re, A_A_im, A_B_re, A_B_im, A_C_re, A_C_im, A_log_dt, A_Dskip)
    h2 = h + _B_ref(_layernorm(h, axis=-1), B_w1, B_b1, B_w2, B_b2)
    return h2
```

```asm
; @launch grid=(256,1,1) block=(512,1,1) lds=163840
.amdgcn_target "amdgcn-amd-amdhsa--gfx950"
.text
.globl sequential_preLN__ssm_conv_s4__dense_activation_squared_relu__prompt_kernel
.p2align 8
.type sequential_preLN__ssm_conv_s4__dense_activation_squared_relu__prompt_kernel,@function
sequential_preLN__ssm_conv_s4__dense_activation_squared_relu__prompt_kernel:
    s_cmp_ge_u32 s2, 256
    s_cbranch_scc1 sequential_preLN__ssm_conv_s4__dense_activation_squared_relu__prompt_kernel_done1
    s_getpc_b64 s[62:63]
    s_lshr_b32 s29, s2, 3
    s_lshl_b32 s3, s29, 10
    s_min_u32 s3, s3, sequential_preLN__ssm_conv_s4__dense_activation_squared_relu__prompt_kernel_done1 - sequential_preLN__ssm_conv_s4__dense_activation_squared_relu__prompt_kernel - 1040
    v_lshl_add_u32 v252, v0, 1, s3
    global_load_ushort v253, v252, s[62:63]
    s_load_dwordx16 s[4:19], s[0:1], 0
    s_load_dwordx4 s[96:99], s[0:1], 120
    s_load_dwordx2 s[20:21], s[0:1], 64
    s_load_dwordx8 s[40:47], s[0:1], 80
    s_load_dwordx2 s[50:51], s[0:1], 112
    s_memrealtime s[60:61]
    v_xor_b32 v0, 0x100, v0
    v_lshrrev_b32 v2, 6, v0
    v_and_b32 v1, 63, v0
    v_readfirstlane_b32 s24, v2
    s_and_b32 s28, s2, 7
    s_lshl_b32 s25, s28, 5
    s_add_u32 s25, s25, s29
    v_mov_b32 v102, 0
    v_lshlrev_b32 v2, 4, v1
    s_mov_b32 s55, 0xffff0000
    s_and_b32 s27, s24, 3
    s_cmp_lt_u32 s24, 4
    s_cbranch_scc1 sequential_preLN__ssm_conv_s4__dense_activation_squared_relu__prompt_kernel_kside3
    v_lshrrev_b32 v24, 2, v1
    v_and_b32 v25, 3, v1
    v_lshrrev_b32 v29, 4, v1
    v_xor_b32 v26, v25, v29
    v_lshlrev_b32 v101, 10, v24
    v_lshl_add_u32 v101, v26, 4, v101
    s_lshr_b32 s32, s2, 2
    s_lshl_b32 s32, s32, 15
    s_and_b32 s33, s2, 3
    s_lshl_b32 s33, s33, 8
    s_add_u32 s32, s32, s33
    s_lshl_b32 s33, s27, 6
    s_add_u32 s32, s32, s33
    v_add_u32 v101, s32, v101
    v_add_u32 v103, 16384, v101
    s_mul_i32 s63, s27, 6144
    s_add_u32 s63, s63, 56320
    s_mov_b32 m0, s63
    s_add_u32 s33, s63, 1024
    s_lshl_b32 s30, s2, 13
    s_lshl_b32 s34, s27, 11
    s_add_u32 s30, s30, s34
    v_add_u32 v100, s30, v2
    v_mov_b32 v99, 136360
    ds_write_b32 v99, v102
    ds_write_b32 v99, v102 offset:4
    ds_write_b32 v99, v102 offset:8
    ds_write_b32 v99, v102 offset:12
    ds_write_b32 v99, v102 offset:16
    s_or_b32 s30, s2, s27
    s_waitcnt lgkmcnt(0)
    s_cmp_lg_u32 s30, 0
    s_cbranch_scc1 sequential_preLN__ssm_conv_s4__dense_activation_squared_relu__prompt_kernel_nn5
    s_lshl_b32 s60, s60, 3
    s_or_b32 s60, s60, 3
    v_mov_b32 v116, s60
    v_mov_b32 v117, 0
    s_mov_b64 exec, 1
    global_atomic_cmpswap v102, v[116:117], s[96:97] sc1
    s_mov_b64 exec, -1
sequential_preLN__ssm_conv_s4__dense_activation_squared_relu__prompt_kernel_nn5:
    global_load_lds_dwordx4 v101, s[4:5]
    s_mov_b32 m0, s33
    s_nop 0
    global_load_lds_dwordx4 v103, s[4:5]
    global_load_dwordx4 v[112:115], v100, s[4:5]
    global_load_dwordx4 v[92:95], v100, s[4:5] offset:1024
    s_branch sequential_preLN__ssm_conv_s4__dense_activation_squared_relu__prompt_kernel_mside2
sequential_preLN__ssm_conv_s4__dense_activation_squared_relu__prompt_kernel_kside3:
    s_lshl_b32 s30, s25, 9
    v_lshl_add_u32 v3, v0, 1, s30
    s_lshl_b32 s26, s25, 2
    s_waitcnt lgkmcnt(0)
    global_load_short_d16_hi v4, v3, s[6:7]
    global_load_short_d16_hi v5, v3, s[8:9]
    global_load_short_d16_hi v6, v3, s[10:11]
    global_load_short_d16_hi v7, v3, s[12:13]
    global_load_short_d16_hi v8, v3, s[14:15]
    global_load_short_d16_hi v9, v3, s[16:17]
    s_barrier
    s_load_dword s30, s[18:19], s26
    s_load_dword s31, s[20:21], s26
    s_mov_b32 s36, s98
    s_mov_b32 s37, s99
    s_mov_b32 s38, 0x2000000
    s_mov_b32 s39, 0x00020000
    s_mov_b32 s100, s42
    s_mov_b32 s101, s43
    s_mov_b32 s48, s46
    s_mov_b32 s49, s47
    s_and_b32 s45, s29, 7
    s_lshr_b32 s52, s28, 1
    s_lshl_b32 s52, s52, 3
    s_add_u32 s52, s52, s45
    s_mov_b32 s45, 0
    s_and_b32 s53, s28, 1
    s_lshl_b32 s53, s53, 2
    s_lshr_b32 s33, s29, 3
    s_add_u32 s53, s53, s33
    s_lshl_b32 s52, s28, 2
    s_and_b32 s33, s29, 3
    s_add_u32 s52, s52, s33
    s_lshr_b32 s53, s29, 2
    s_lshr_b32 s33, s53, 1
    s_lshl_b32 s33, s33, 1
    s_add_u32 s3, s24, s33
    s_and_b32 s3, s3, 7
    s_mov_b32 s57, 0
    s_mul_i32 s54, s53, 7
    s_min_u32 s33, s24, 6
    s_add_u32 s54, s54, s33
    s_mov_b32 s40, s50
    s_mov_b32 s41, s51
    s_mov_b32 s42, 0x200000
    s_mov_b32 s43, 0x00020000
    s_lshl_b32 s33, s54, 15
    s_add_u32 s33, s33, 0x100000
    s_add_u32 s8, s98, s33
    s_addc_u32 s9, s99, 0
    s_cmp_eq_u32 s24, 7
    s_cselect_b32 s10, 0, 0x8000
    s_mov_b32 s11, 0x00020000
    s_lshl_b32 s56, s45, 12
    s_mul_i32 s33, s53, 229376
    s_mul_i32 s34, s3, 28672
    s_add_u32 s33, s33, s34
    s_add_u32 s33, s33, 0x300000
    s_add_u32 s12, s98, s33
    s_addc_u32 s13, s99, 0
    s_movk_i32 s14, 0x7000
    s_mov_b32 s15, 0x00020000
    s_mul_i32 s46, s24, 8224
    s_add_u32 s46, s46, 51712
    s_mul_i32 s44, s27, 6144
    s_add_u32 s44, s44, 114880
    s_lshr_b32 s33, s54, 1
    s_lshl_b32 s33, s33, 10
    s_add_u32 s33, s33, 131072
    v_and_b32 v117, 7, v1
    v_lshl_add_u32 v117, v117, 7, s33
    v_ffbh_u32 v24, v1
    v_sub_u32 v24, 31, v24
    v_lshlrev_b32 v24, v24, 1
    v_and_b32 v24, 56, v24
    v_max_u32 v25, 8, v24
    v_mul_u32_u24 v25, s24, v25
    v_mad_u32_u24 v24, v24, 3, v1
    v_add_u32 v24, v24, v25
    v_lshlrev_b32 v23, 4, v24
    v_lshlrev_b32 v24, 3, v24
    v_mov_b32 v25, 137420
    v_mov_b32 v29, 128
    s_mov_b32 s33, 0xffff
    s_mov_b32 s34, 4294950272
    v_add_u32 v26, 7, v24
    v_cvt_f32_u32 v27, v26
    v_cvt_pk_bf16_f32 v27, v27, v27
    v_and_b32 v27, s33, v27
    v_add_u32 v27, s34, v27
    v_med3_i32 v27, v26, v27, v29
    v_lshl_add_u32 v12, v27, 2, v25
    v_add_u32 v26, 6, v24
    v_cvt_f32_u32 v27, v26
    v_cvt_pk_bf16_f32 v27, v27, v27
    v_and_b32 v27, s33, v27
    v_add_u32 v27, s34, v27
    v_med3_i32 v27, v26, v27, v29
    v_lshl_add_u32 v13, v27, 2, v25
    v_add_u32 v26, 5, v24
    v_cvt_f32_u32 v27, v26
    v_cvt_pk_bf16_f32 v27, v27, v27
    v_and_b32 v27, s33, v27
    v_add_u32 v27, s34, v27
    v_med3_i32 v27, v26, v27, v29
    v_lshl_add_u32 v14, v27, 2, v25
    v_add_u32 v26, 4, v24
    v_cvt_f32_u32 v27, v26
    v_cvt_pk_bf16_f32 v27, v27, v27
    v_and_b32 v27, s33, v27
    v_add_u32 v27, s34, v27
    v_med3_i32 v27, v26, v27, v29
    v_lshl_add_u32 v15, v27, 2, v25
    v_add_u32 v26, 3, v24
    v_cvt_f32_u32 v27, v26
    v_cvt_pk_bf16_f32 v27, v27, v27
    v_and_b32 v27, s33, v27
    v_add_u32 v27, s34, v27
    v_med3_i32 v27, v26, v27, v29
    v_lshl_add_u32 v16, v27, 2, v25
    v_add_u32 v26, 2, v24
    v_cvt_f32_u32 v27, v26
    v_cvt_pk_bf16_f32 v27, v27, v27
    v_and_b32 v27, s33, v27
    v_add_u32 v27, s34, v27
    v_med3_i32 v27, v26, v27, v29
    v_lshl_add_u32 v17, v27, 2, v25
    v_add_u32 v26, 1, v24
    v_cvt_f32_u32 v27, v26
    v_cvt_pk_bf16_f32 v27, v27, v27
    v_and_b32 v27, s33, v27
    v_add_u32 v27, s34, v27
    v_med3_i32 v27, v26, v27, v29
    v_lshl_add_u32 v18, v27, 2, v25
    v_add_u32 v26, 0, v24
    v_cvt_f32_u32 v27, v26
    v_cvt_pk_bf16_f32 v27, v27, v27
    v_and_b32 v27, s33, v27
    v_add_u32 v27, s34, v27
    v_med3_i32 v27, v26, v27, v29
    v_lshl_add_u32 v19, v27, 2, v25
    v_add_u32 v26, -1, v24
    v_max_i32 v27, 0, v26
    v_max_i32 v26, -1, v26
    v_cvt_f32_u32 v27, v27
    v_cvt_pk_bf16_f32 v27, v27, v27
    v_and_b32 v27, s33, v27
    v_add_u32 v27, s34, v27
    v_med3_i32 v27, v26, v27, v29
    v_lshl_add_u32 v20, v27, 2, v25
    v_add_u32 v26, -2, v24
    v_max_i32 v27, 0, v26
    v_max_i32 v26, -1, v26
    v_cvt_f32_u32 v27, v27
    v_cvt_pk_bf16_f32 v27, v27, v27
    v_and_b32 v27, s33, v27
    v_add_u32 v27, s34, v27
    v_med3_i32 v27, v26, v27, v29
    v_lshl_add_u32 v21, v27, 2, v25
    v_add_u32 v26, -3, v24
    v_max_i32 v27, 0, v26
    v_max_i32 v26, -1, v26
    v_cvt_f32_u32 v27, v27
    v_cvt_pk_bf16_f32 v27, v27, v27
    v_and_b32 v27, s33, v27
    v_add_u32 v27, s34, v27
    v_med3_i32 v27, v26, v27, v29
    v_lshl_add_u32 v22, v27, 2, v25
    v_lshlrev_b32 v10, 2, v0
    s_lshr_b32 s32, s24, 1
    s_lshl_b32 s32, s32, 4
    s_waitcnt lgkmcnt(0)
    s_lshr_b32 s33, s30, s32
    s_lshl_b32 s33, s33, 16
    v_mov_b32 v11, s33
    v_mul_f32 v11, 0x3fb8aa3b, v11
    v_exp_f32 v11, v11
    s_lshr_b32 s31, s31, s32
    s_lshl_b32 s31, s31, 16
    s_and_b32 s63, s24, 1
    s_cmp_eq_u32 s63, 0
    s_cselect_b32 s31, s31, 0
    v_cvt_pk_bf16_f32 v11, v11, v11
    v_lshlrev_b32 v11, 16, v11
    v_and_b32 v26, 31, v1
    v_lshrrev_b32 v27, 5, v1
    v_min_u32 v28, 20, v26
    s_lshl_b32 s32, s24, 8
    v_mul_u32_u24 v28, 1040, v28
    v_mul_u32_u24 v29, 1040, v26
    v_lshl_add_u32 v30, v27, 4, s32
    v_add_u32 v110, v28, v30
    v_add_u32 v111, v29, v30
    s_mul_i32 s32, s24, 2816
    s_add_u32 s32, s32, 137424
    v_lshlrev_b32 v30, 5, v26
    v_lshl_add_u32 v30, v27, 4, v30
    v_add_u32 v112, s32, v30
    v_cmp_eq_u32 vcc, 0, v27
    v_lshlrev_b32 v31, 4, v26
    v_lshlrev_b32 v32, 3, v26
    v_add_u32 v33, 1032, v31
    v_add_u32 v31, 1024, v31
    v_add_u32 v34, 1792, v32
    v_add_u32 v32, 1536, v32
    v_cndmask_b32 v31, v32, v31, vcc
    v_cndmask_b32 v33, v34, v33, vcc
    v_add_u32 v113, s32, v31
    v_add_u32 v114, s32, v33
    v_lshl_add_u32 v115, v26, 2, s32
    s_sub_u32 s34, s32, 8
    v_mov_b32 v116, s34
    s_waitcnt vmcnt(0)
    v_mul_f32 v4, v4, v11
    v_mul_f32 v5, v5, v11
    v_mul_f32 v6, v6, v11
    v_mul_f32 v7, v7, v11
    v_mul_f32 v4, 0x3fb8aa3b, v4
    v_mul_f32 v5, 0x3e22f983, v5
    v_mul_f32 v52, 0x3f800000, v4
    v_mul_f32 v53, 0x3f800000, v5
    v_exp_f32 v52, v52
    v_rndne_f32 v54, v53
    v_sub_f32 v53, v53, v54
    v_cos_f32 v32, v53
    v_sin_f32 v33, v53
    s_nop 0
    v_mul_f32 v32, v32, v52
    v_mul_f32 v33, v33, v52
    v_mul_f32 v56, 0x43800000, v4
    v_mul_f32 v57, 0x43800000, v5
    v_exp_f32 v56, v56
    v_rndne_f32 v58, v57
    v_sub_f32 v57, v57, v58
    v_cos_f32 v26, v57
    v_sin_f32 v27, v57
    s_nop 0
    v_mul_f32 v26, v26, v56
    v_mul_f32 v27, v27, v56
    v_pk_mul_f32 v[30:31], v[8:9], v[6:7] op_sel:[0,0] op_sel_hi:[0,1]
    v_pk_fma_f32 v[30:31], v[8:9], v[6:7], v[30:31] op_sel:[1,1,0] op_sel_hi:[1,0,1] neg_lo:[0,1,0]
    v_mul_f32 v52, 0x40800000, v4
    v_mul_f32 v53, 0x40800000, v5
    v_exp_f32 v52, v52
    v_rndne_f32 v54, v53
    v_sub_f32 v53, v53, v54
    v_cos_f32 v24, v53
    v_sin_f32 v25, v53
    s_nop 0
    v_mul_f32 v24, v24, v52
    v_mul_f32 v25, v25, v52
    v_mul_f32 v56, 0x42000000, v4
    v_mul_f32 v57, 0x42000000, v5
    v_exp_f32 v56, v56
    v_rndne_f32 v58, v57
    v_sub_f32 v57, v57, v58
    v_cos_f32 v28, v57
    v_sin_f32 v29, v57
    s_nop 0
    v_mul_f32 v28, v28, v56
    v_mul_f32 v29, v29, v56
    v_pk_mul_f32 v[34:35], v[32:33], v[32:33] op_sel:[0,0] op_sel_hi:[0,1]
    v_pk_fma_f32 v[34:35], v[32:33], v[32:33], v[34:35] op_sel:[1,1,0] op_sel_hi:[1,0,1] neg_lo:[0,1,0]
    v_pk_mul_f32 v[38:39], v[24:25], v[24:25] op_sel:[0,0] op_sel_hi:[0,1]
    v_pk_fma_f32 v[38:39], v[24:25], v[24:25], v[38:39] op_sel:[1,1,0] op_sel_hi:[1,0,1] neg_lo:[0,1,0]
    v_pk_mul_f32 v[66:67], v[30:31], v[24:25] op_sel:[0,0] op_sel_hi:[0,1]
    v_pk_fma_f32 v[66:67], v[30:31], v[24:25], v[66:67] op_sel:[1,1,0] op_sel_hi:[1,0,1] neg_lo:[0,1,0]
    v_pk_mul_f32 v[60:61], v[30:31], v[32:33] op_sel:[0,0] op_sel_hi:[0,1]
    v_pk_fma_f32 v[60:61], v[30:31], v[32:33], v[60:61] op_sel:[1,1,0] op_sel_hi:[1,0,1] neg_lo:[0,1,0]
    v_pk_mul_f32 v[62:63], v[30:31], v[34:35] op_sel:[0,0] op_sel_hi:[0,1]
    v_pk_fma_f32 v[62:63], v[30:31], v[34:35], v[62:63] op_sel:[1,1,0] op_sel_hi:[1,0,1] neg_lo:[0,1,0]
    v_cvt_pk_bf16_f32 v53, v30, -v31
    ds_write_b32 v10, v53 offset:20800
    v_pk_mul_f32 v[74:75], v[66:67], v[24:25] op_sel:[0,0] op_sel_hi:[0,1]
    v_pk_fma_f32 v[74:75], v[66:67], v[24:25], v[74:75] op_sel:[1,1,0] op_sel_hi:[1,0,1] neg_lo:[0,1,0]
    v_pk_mul_f32 v[64:65], v[60:61], v[34:35] op_sel:[0,0] op_sel_hi:[0,1]
    v_pk_fma_f32 v[64:65], v[60:61], v[34:35], v[64:65] op_sel:[1,1,0] op_sel_hi:[1,0,1] neg_lo:[0,1,0]
    v_pk_mul_f32 v[40:41], v[38:39], v[38:39] op_sel:[0,0] op_sel_hi:[0,1]
    v_pk_fma_f32 v[40:41], v[38:39], v[38:39], v[40:41] op_sel:[1,1,0] op_sel_hi:[1,0,1] neg_lo:[0,1,0]
    v_cvt_pk_bf16_f32 v54, v66, -v67
    ds_write_b32 v10, v54 offset:3120
    v_pk_mul_f32 v[82:83], v[74:75], v[26:27] op_sel:[0,0] op_sel_hi:[0,1]
    v_pk_fma_f32 v[82:83], v[74:75], v[26:27], v[82:83] op_sel:[1,1,0] op_sel_hi:[1,0,1] neg_lo:[0,1,0]
    v_pk_mul_f32 v[78:79], v[66:67], v[26:27] op_sel:[0,0] op_sel_hi:[0,1]
    v_pk_fma_f32 v[78:79], v[66:67], v[26:27], v[78:79] op_sel:[1,1,0] op_sel_hi:[1,0,1] neg_lo:[0,1,0]
    v_pk_mul_f32 v[42:43], v[40:41], v[38:39] op_sel:[0,0] op_sel_hi:[0,1]
    v_pk_fma_f32 v[42:43], v[40:41], v[38:39], v[42:43] op_sel:[1,1,0] op_sel_hi:[1,0,1] neg_lo:[0,1,0]
    v_cvt_pk_bf16_f32 v55, v60, -v61
    ds_write_b32 v10, v55 offset:0
    v_pk_mul_f32 v[86:87], v[82:83], v[26:27] op_sel:[0,0] op_sel_hi:[0,1]
    v_pk_fma_f32 v[86:87], v[82:83], v[26:27], v[86:87] op_sel:[1,1,0] op_sel_hi:[1,0,1] neg_lo:[0,1,0]
    v_pk_mul_f32 v[68:69], v[60:61], v[24:25] op_sel:[0,0] op_sel_hi:[0,1]
    v_pk_fma_f32 v[68:69], v[60:61], v[24:25], v[68:69] op_sel:[1,1,0] op_sel_hi:[1,0,1] neg_lo:[0,1,0]
    v_cvt_pk_bf16_f32 v52, v62, -v63
    ds_write_b32 v10, v52 offset:1040
    v_cvt_pk_bf16_f32 v53, v74, -v75
    ds_write_b32 v10, v53 offset:7280
    v_pk_mul_f32 v[90:91], v[86:87], v[26:27] op_sel:[0,0] op_sel_hi:[0,1]
    v_pk_fma_f32 v[90:91], v[86:87], v[26:27], v[90:91] op_sel:[1,1,0] op_sel_hi:[1,0,1] neg_lo:[0,1,0]
    v_pk_mul_f32 v[70:71], v[62:63], v[24:25] op_sel:[0,0] op_sel_hi:[0,1]
    v_pk_fma_f32 v[70:71], v[62:63], v[24:25], v[70:71] op_sel:[1,1,0] op_sel_hi:[1,0,1] neg_lo:[0,1,0]
    v_cvt_pk_bf16_f32 v54, v64, -v65
    ds_write_b32 v10, v54 offset:2080
    v_cvt_pk_bf16_f32 v55, v82, -v83
    ds_write_b32 v10, v55 offset:11440
    v_pk_mul_f32 v[92:93], v[90:91], v[26:27] op_sel:[0,0] op_sel_hi:[0,1]
    v_pk_fma_f32 v[92:93], v[90:91], v[26:27], v[92:93] op_sel:[1,1,0] op_sel_hi:[1,0,1] neg_lo:[0,1,0]
    v_pk_mul_f32 v[72:73], v[64:65], v[24:25] op_sel:[0,0] op_sel_hi:[0,1]
    v_pk_fma_f32 v[72:73], v[64:65], v[24:25], v[72:73] op_sel:[1,1,0] op_sel_hi:[1,0,1] neg_lo:[0,1,0]
    v_cvt_pk_bf16_f32 v52, v78, -v79
    ds_write_b32 v10, v52 offset:9360
    v_cvt_pk_bf16_f32 v53, v86, -v87
    ds_write_b32 v10, v53 offset:13520
    v_pk_mul_f32 v[94:95], v[92:93], v[26:27] op_sel:[0,0] op_sel_hi:[0,1]
    v_pk_fma_f32 v[94:95], v[92:93], v[26:27], v[94:95] op_sel:[1,1,0] op_sel_hi:[1,0,1] neg_lo:[0,1,0]
    v_pk_mul_f32 v[76:77], v[62:63], v[26:27] op_sel:[0,0] op_sel_hi:[0,1]
    v_pk_fma_f32 v[76:77], v[62:63], v[26:27], v[76:77] op_sel:[1,1,0] op_sel_hi:[1,0,1] neg_lo:[0,1,0]
    v_cvt_pk_bf16_f32 v54, v68, -v69
    ds_write_b32 v10, v54 offset:4160
    v_cvt_pk_bf16_f32 v55, v90, -v91
    ds_write_b32 v10, v55 offset:15600
    v_pk_mul_f32 v[96:97], v[94:95], v[26:27] op_sel:[0,0] op_sel_hi:[0,1]
    v_pk_fma_f32 v[96:97], v[94:95], v[26:27], v[96:97] op_sel:[1,1,0] op_sel_hi:[1,0,1] neg_lo:[0,1,0]
    v_pk_mul_f32 v[80:81], v[70:71], v[26:27] op_sel:[0,0] op_sel_hi:[0,1]
    v_pk_fma_f32 v[80:81], v[70:71], v[26:27], v[80:81] op_sel:[1,1,0] op_sel_hi:[1,0,1] neg_lo:[0,1,0]
    v_cvt_pk_bf16_f32 v52, v70, -v71
    ds_write_b32 v10, v52 offset:5200
    v_cvt_pk_bf16_f32 v53, v92, -v93
    ds_write_b32 v10, v53 offset:16640
    v_pk_mul_f32 v[98:99], v[96:97], v[26:27] op_sel:[0,0] op_sel_hi:[0,1]
    v_pk_fma_f32 v[98:99], v[96:97], v[26:27], v[98:99] op_sel:[1,1,0] op_sel_hi:[1,0,1] neg_lo:[0,1,0]
    v_pk_mul_f32 v[84:85], v[78:79], v[26:27] op_sel:[0,0] op_sel_hi:[0,1]
    v_pk_fma_f32 v[84:85], v[78:79], v[26:27], v[84:85] op_sel:[1,1,0] op_sel_hi:[1,0,1] neg_lo:[0,1,0]
    v_cvt_pk_bf16_f32 v54, v72, -v73
    ds_write_b32 v10, v54 offset:6240
    v_cvt_pk_bf16_f32 v55, v94, -v95
    ds_write_b32 v10, v55 offset:17680
    v_pk_mul_f32 v[88:89], v[84:85], v[26:27] op_sel:[0,0] op_sel_hi:[0,1]
    v_pk_fma_f32 v[88:89], v[84:85], v[26:27], v[88:89] op_sel:[1,1,0] op_sel_hi:[1,0,1] neg_lo:[0,1,0]
    v_cvt_pk_bf16_f32 v52, v76, -v77
    ds_write_b32 v10, v52 offset:8320
    v_cvt_pk_bf16_f32 v53, v96, -v97
    ds_write_b32 v10, v53 offset:18720
    v_cvt_pk_bf16_f32 v54, v80, -v81
    ds_write_b32 v10, v54 offset:10400
    v_cvt_pk_bf16_f32 v55, v98, -v99
    ds_write_b32 v10, v55 offset:19760
    v_cvt_pk_bf16_f32 v52, v84, -v85
    ds_write_b32 v10, v52 offset:12480
    v_cvt_pk_bf16_f32 v53, v88, -v89
    ds_write_b32 v10, v53 offset:14560
    v_mov_b32 v36, 1.0
    v_mov_b32 v37, 0
    s_mov_b32 s32, 0
    ds_read_b128 v[192:195], v110 offset:0
    ds_read_b128 v[196:199], v110 offset:32
    ds_read_b128 v[200:203], v110 offset:64
    ds_read_b128 v[204:207], v110 offset:96
    ds_read_b128 v[208:211], v110 offset:128
    ds_read_b128 v[212:215], v110 offset:160
    ds_read_b128 v[216:219], v110 offset:192
    ds_read_b128 v[220:223], v110 offset:224
sequential_preLN__ssm_conv_s4__dense_activation_squared_relu__prompt_kernel_yloop6:
    v_pk_mul_f32 v[44:45], v[36:37], v[28:29] op_sel:[0,0] op_sel_hi:[0,1]
    v_pk_fma_f32 v[44:45], v[36:37], v[28:29], v[44:45] op_sel:[1,1,0] op_sel_hi:[1,0,1] neg_lo:[0,1,0]
    v_cvt_pk_bf16_f32 v52, v36, v37
    ds_write_b32 v10, v52 offset:21840
    v_pk_mul_f32 v[46:47], v[38:39], v[28:29] op_sel:[0,0] op_sel_hi:[0,1]
    v_pk_fma_f32 v[46:47], v[38:39], v[28:29], v[46:47] op_sel:[1,1,0] op_sel_hi:[1,0,1] neg_lo:[0,1,0]
    v_cvt_pk_bf16_f32 v53, v38, v39
    ds_write_b32 v10, v53 offset:22880
    v_pk_mul_f32 v[48:49], v[40:41], v[28:29] op_sel:[0,0] op_sel_hi:[0,1]
    v_pk_fma_f32 v[48:49], v[40:41], v[28:29], v[48:49] op_sel:[1,1,0] op_sel_hi:[1,0,1] neg_lo:[0,1,0]
    v_cvt_pk_bf16_f32 v54, v40, v41
    ds_write_b32 v10, v54 offset:23920
    v_pk_mul_f32 v[50:51], v[42:43], v[28:29] op_sel:[0,0] op_sel_hi:[0,1]
    v_pk_fma_f32 v[50:51], v[42:43], v[28:29], v[50:51] op_sel:[1,1,0] op_sel_hi:[1,0,1] neg_lo:[0,1,0]
    v_cvt_pk_bf16_f32 v55, v42, v43
    ds_write_b32 v10, v55 offset:24960
    v_pk_mul_f32 v[36:37], v[44:45], v[28:29] op_sel:[0,0] op_sel_hi:[0,1]
    v_pk_fma_f32 v[36:37], v[44:45], v[28:29], v[36:37] op_sel:[1,1,0] op_sel_hi:[1,0,1] neg_lo:[0,1,0]
    v_cvt_pk_bf16_f32 v52, v44, v45
    ds_write_b32 v10, v52 offset:26000
    v_pk_mul_f32 v[38:39], v[46:47], v[28:29] op_sel:[0,0] op_sel_hi:[0,1]
    v_pk_fma_f32 v[38:39], v[46:47], v[28:29], v[38:39] op_sel:[1,1,0] op_sel_hi:[1,0,1] neg_lo:[0,1,0]
    v_cvt_pk_bf16_f32 v53, v46, v47
    ds_write_b32 v10, v53 offset:27040
    v_pk_mul_f32 v[40:41], v[48:49], v[28:29] op_sel:[0,0] op_sel_hi:[0,1]
    v_pk_fma_f32 v[40:41], v[48:49], v[28:29], v[40:41] op_sel:[1,1,0] op_sel_hi:[1,0,1] neg_lo:[0,1,0]
    v_cvt_pk_bf16_f32 v54, v48, v49
    ds_write_b32 v10, v54 offset:28080
    v_pk_mul_f32 v[42:43], v[50:51], v[28:29] op_sel:[0,0] op_sel_hi:[0,1]
    v_pk_fma_f32 v[42:43], v[50:51], v[28:29], v[42:43] op_sel:[1,1,0] op_sel_hi:[1,0,1] neg_lo:[0,1,0]
    v_cvt_pk_bf16_f32 v55, v50, v51
    ds_write_b32 v10, v55 offset:29120
    v_add_u32 v10, 8320, v10
    s_add_u32 s32, s32, 1
    s_cmp_lt_u32 s32, 4
    s_cbranch_scc1 sequential_preLN__ssm_conv_s4__dense_activation_squared_relu__prompt_kernel_yloop6
    s_waitcnt lgkmcnt(6)
    ds_read_b128 v[224:227], v111 offset:21840
    ds_read_b128 v[228:231], v111 offset:21872
    ds_read_b128 v[232:235], v111 offset:21904
    ds_read_b128 v[236:239], v111 offset:21936
    ds_read_b128 v[240:243], v111 offset:21968
    ds_read_b128 v[244:247], v111 offset:22000
    ds_read_b128 v[248:251], v111 offset:22032
    ds_read_b128 v[252:255], v111 offset:22064
    s_waitcnt lgkmcnt(7)
    v_mfma_f32_32x32x16_bf16 v[36:51], v[192:195], v[224:227], 0
    s_waitcnt lgkmcnt(6)
    v_mfma_f32_32x32x16_bf16 v[36:51], v[196:199], v[228:231], v[36:51]
    s_waitcnt lgkmcnt(5)
    v_mfma_f32_32x32x16_bf16 v[36:51], v[200:203], v[232:235], v[36:51]
    s_waitcnt lgkmcnt(4)
    v_mfma_f32_32x32x16_bf16 v[36:51], v[204:207], v[236:239], v[36:51]
    s_waitcnt lgkmcnt(3)
    v_mfma_f32_32x32x16_bf16 v[36:51], v[208:211], v[240:243], v[36:51]
    s_waitcnt lgkmcnt(2)
    v_mfma_f32_32x32x16_bf16 v[36:51], v[212:215], v[244:247], v[36:51]
    s_waitcnt lgkmcnt(1)
    v_mfma_f32_32x32x16_bf16 v[36:51], v[216:219], v[248:251], v[36:51]
    s_waitcnt lgkmcnt(0)
    v_mfma_f32_32x32x16_bf16 v[36:51], v[220:223], v[252:255], v[36:51]
    v_and_b32 v26, 15, v1
    v_lshrrev_b32 v27, 4, v1
    s_lshr_b32 s32, s24, 1
    v_and_b32 v24, 3, v26
    v_mul_u32_u24 v24, 4160, v24
    v_lshrrev_b32 v25, 2, v26
    v_sub_u32 v25, v25, v27
    v_lshl_add_u32 v24, v25, 4, v24
    s_mul_i32 s34, s32, 16640
    s_lshl_b32 s35, s63, 8
    s_add_u32 s34, s34, s35
    s_add_u32 s34, s34, 64
    v_add_u32 v125, s34, v24
    v_mov_b32 v34, 0
    s_nop 9
    ds_write_b128 v112, v[36:39]
    v_add_f32 v35, s31, v44
    ds_write_b64 v113, v[40:41]
    ds_write_b64 v114, v[42:43]
    s_mov_b32 exec_hi, 0
    ds_write_b32 v115, v44 offset:2048
    ds_write_b32 v115, v45 offset:2176
    ds_write_b32 v115, v46 offset:2304
    ds_write_b32 v115, v47 offset:2432
    s_mov_b32 exec_lo, 0
    s_mov_b32 exec_hi, 1
    ds_write_b64 v116, v[34:35]
    s_mov_b64 exec, -1
    v_mov_b32 v5, 136352
    v_mov_b32 v4, v117
    s_waitcnt lgkmcnt(0)
    s_barrier
    ds_read_b32 v5, v5
    ds_read2st64_b32 v[30:31], v12 offset0:0 offset1:11
    ds_read2st64_b32 v[32:33], v13 offset0:0 offset1:11
    ds_read2st64_b32 v[34:35], v14 offset0:0 offset1:11
    ds_read2st64_b32 v[36:37], v15 offset0:0 offset1:11
    ds_read2st64_b32 v[38:39], v16 offset0:0 offset1:11
    ds_read2st64_b32 v[40:41], v17 offset0:0 offset1:11
    ds_read2st64_b32 v[42:43], v18 offset0:0 offset1:11
    ds_read2st64_b32 v[44:45], v19 offset0:0 offset1:11
    ds_read2st64_b32 v[46:47], v20 offset0:0 offset1:11
    ds_read2st64_b32 v[48:49], v21 offset0:0 offset1:11
    ds_read2st64_b32 v[50:51], v22 offset0:0 offset1:11
    ds_read2st64_b32 v[52:53], v12 offset0:22 offset1:33
    ds_read2st64_b32 v[54:55], v13 offset0:22 offset1:33
    ds_read2st64_b32 v[56:57], v14 offset0:22 offset1:33
    s_waitcnt lgkmcnt(3)
    ds_read2st64_b32 v[58:59], v15 offset0:22 offset1:33
    ds_read2st64_b32 v[60:61], v16 offset0:22 offset1:33
    ds_read2st64_b32 v[62:63], v17 offset0:22 offset1:33
    ds_read2st64_b32 v[64:65], v18 offset0:22 offset1:33
    ds_read2st64_b32 v[66:67], v19 offset0:22 offset1:33
    ds_read2st64_b32 v[68:69], v20 offset0:22 offset1:33
    ds_read2st64_b32 v[70:71], v21 offset0:22 offset1:33
    ds_read2st64_b32 v[72:73], v22 offset0:22 offset1:33
    v_add_f32 v30, v30, v31
    v_add_f32 v32, v32, v33
    v_add_f32 v34, v34, v35
    v_add_f32 v36, v36, v37
    v_add_f32 v38, v38, v39
    v_add_f32 v40, v40, v41
    v_add_f32 v42, v42, v43
    v_add_f32 v44, v44, v45
    v_add_f32 v46, v46, v47
    v_add_f32 v48, v48, v49
    v_add_f32 v50, v50, v51
    v_cvt_pk_bf16_f32 v88, v30, v32
    v_cvt_pk_bf16_f32 v89, v34, v36
    v_cvt_pk_bf16_f32 v90, v38, v40
    v_cvt_pk_bf16_f32 v91, v42, v44
    ds_write_b128 v23, v[88:91] offset:12544
    v_cvt_pk_bf16_f32 v84, v32, v34
    v_cvt_pk_bf16_f32 v85, v36, v38
    v_cvt_pk_bf16_f32 v86, v40, v42
    v_cvt_pk_bf16_f32 v87, v44, v46
    ds_write_b128 v23, v[84:87] offset:8384
    v_cvt_pk_bf16_f32 v80, v34, v36
    v_cvt_pk_bf16_f32 v81, v38, v40
    v_cvt_pk_bf16_f32 v82, v42, v44
    v_cvt_pk_bf16_f32 v83, v46, v48
    ds_write_b128 v23, v[80:83] offset:4224
    v_cvt_pk_bf16_f32 v76, v36, v38
    v_cvt_pk_bf16_f32 v77, v40, v42
    v_cvt_pk_bf16_f32 v78, v44, v46
    v_cvt_pk_bf16_f32 v79, v48, v50
    ds_write_b128 v23, v[76:79] offset:64
    s_waitcnt lgkmcnt(4)
    v_add_f32 v52, v52, v53
    v_add_f32 v54, v54, v55
    v_add_f32 v56, v56, v57
    v_add_f32 v58, v58, v59
    v_add_f32 v60, v60, v61
    v_add_f32 v62, v62, v63
    v_add_f32 v64, v64, v65
    v_add_f32 v66, v66, v67
    v_add_f32 v68, v68, v69
    v_add_f32 v70, v70, v71
    v_add_f32 v72, v72, v73
    v_cvt_pk_bf16_f32 v44, v52, v54
    v_cvt_pk_bf16_f32 v45, v56, v58
    v_cvt_pk_bf16_f32 v46, v60, v62
    v_cvt_pk_bf16_f32 v47, v64, v66
    ds_write_b128 v23, v[44:47] offset:29184
    v_cvt_pk_bf16_f32 v40, v54, v56
    v_cvt_pk_bf16_f32 v41, v58, v60
    v_cvt_pk_bf16_f32 v42, v62, v64
    v_cvt_pk_bf16_f32 v43, v66, v68
    ds_write_b128 v23, v[40:43] offset:25024
    v_cvt_pk_bf16_f32 v36, v56, v58
    v_cvt_pk_bf16_f32 v37, v60, v62
    v_cvt_pk_bf16_f32 v38, v64, v66
    v_cvt_pk_bf16_f32 v39, v68, v70
    ds_write_b128 v23, v[36:39] offset:20864
    v_cvt_pk_bf16_f32 v32, v58, v60
    v_cvt_pk_bf16_f32 v33, v62, v64
    v_cvt_pk_bf16_f32 v34, v66, v68
    v_cvt_pk_bf16_f32 v35, v70, v72
    ds_write_b128 v23, v[32:35] offset:16704
    buffer_load_dword v6, v4, s[36:39], 0 offen sc1
    v_and_b32 v24, 1, v26
    v_mul_u32_u24 v24, 4640, v24
    v_lshrrev_b32 v25, 1, v26
    v_lshl_add_u32 v24, v25, 6, v24
    v_lshl_add_u32 v24, v27, 4, v24
    s_mul_i32 s34, s32, 9280
    s_sub_u32 s34, s34, s35
    s_add_u32 s34, s34, 109760
    v_add_u32 v126, s34, v24
    v_mul_u32_u24 v24, 320, v27
    v_lshl_add_u32 v24, v26, 4, v24
    s_mul_i32 s34, s32, 10256
    s_mul_i32 s35, s63, 5120
    s_add_u32 s34, s34, s35
    s_add_u32 s34, s34, 66048
    v_add_u32 v124, s34, v24
    s_mov_b32 s32, 0
    s_waitcnt vmcnt(0)
sequential_preLN__ssm_conv_s4__dense_activation_squared_relu__prompt_kernel_wl7:
    v_cmp_ne_u32 vcc, v5, v6
    s_add_u32 s32, s32, 1
    s_cbranch_vccz sequential_preLN__ssm_conv_s4__dense_activation_squared_relu__prompt_kernel_wok8
    s_cmp_gt_u32 s32, 30000
    s_cbranch_scc1 sequential_preLN__ssm_conv_s4__dense_activation_squared_relu__prompt_kernel_wok8
    s_sleep 4
    buffer_load_dword v6, v4, s[36:39], 0 offen sc1
    s_waitcnt vmcnt(0)
    s_branch sequential_preLN__ssm_conv_s4__dense_activation_squared_relu__prompt_kernel_wl7
sequential_preLN__ssm_conv_s4__dense_activation_squared_relu__prompt_kernel_wok8:
    buffer_load_dwordx4 v[128:131], v2, s[8:11], s56 offen offset:0 sc1
    buffer_load_dwordx4 v[132:135], v2, s[8:11], s56 offen offset:1024 sc1
    buffer_load_dwordx4 v[136:139], v2, s[8:11], s56 offen offset:2048 sc1
    buffer_load_dwordx4 v[140:143], v2, s[8:11], s56 offen offset:3072 sc1
    s_add_u32 s56, s56, 4096
    s_and_b32 s56, s56, 0x7fff
    s_setprio 2
    s_waitcnt lgkmcnt(0)
    s_barrier
    ds_read_b128 v[40:43], v125 offset:0
    ds_read_b128 v[44:47], v126 offset:192
    ds_read_b128 v[48:51], v126 offset:704
    ds_read_b128 v[52:55], v126 offset:1216
    ds_read_b128 v[56:59], v126 offset:1728
    ds_read_b128 v[60:63], v125 offset:512
    ds_read_b128 v[64:67], v125 offset:1024
    ds_read_b128 v[68:71], v125 offset:1536
    ds_read_b128 v[72:75], v125 offset:64
    ds_read_b128 v[76:79], v126 offset:128
    ds_read_b128 v[80:83], v126 offset:640
    ds_read_b128 v[84:87], v126 offset:1152
    s_waitcnt lgkmcnt(10)
    v_mfma_f32_16x16x32_bf16 v[8:11], v[40:43], v[44:47], 0
    ds_read_b128 v[88:91], v126 offset:1664
    s_waitcnt lgkmcnt(10)
    v_mfma_f32_16x16x32_bf16 v[12:15], v[40:43], v[48:51], 0
    ds_read_b128 v[92:95], v125 offset:576
    buffer_load_dwordx4 v[144:147], v2, s[8:11], s56 offen offset:0 sc1
    s_waitcnt lgkmcnt(10)
    v_mfma_f32_16x16x32_bf16 v[16:19], v[40:43], v[52:55], 0
    ds_read_b128 v[96:99], v125 offset:1088
    s_waitcnt lgkmcnt(10)
    v_mfma_f32_16x16x32_bf16 v[20:23], v[40:43], v[56:59], 0
    ds_read_b128 v[100:103], v125 offset:1600
    s_waitcnt lgkmcnt(10)
    v_mfma_f32_16x16x32_bf16 v[12:15], v[60:63], v[44:47], v[12:15]
    ds_read_b128 v[104:107], v125 offset:128
    v_mfma_f32_16x16x32_bf16 v[16:19], v[60:63], v[48:51], v[16:19]
    ds_read_b128 v[108:111], v126 offset:64
    v_mfma_f32_16x16x32_bf16 v[20:23], v[60:63], v[52:55], v[20:23]
    ds_read_b128 v[112:115], v126 offset:576
    s_waitcnt lgkmcnt(12)
    v_mfma_f32_16x16x32_bf16 v[16:19], v[64:67], v[44:47], v[16:19]
    ds_read_b128 v[116:119], v126 offset:1088
    buffer_load_dwordx4 v[148:151], v2, s[8:11], s56 offen offset:1024 sc1
    v_mfma_f32_16x16x32_bf16 v[20:23], v[64:67], v[48:51], v[20:23]
    ds_read_b128 v[40:43], v126 offset:1600
    s_waitcnt lgkmcnt(13)
    v_mfma_f32_16x16x32_bf16 v[20:23], v[68:71], v[44:47], v[20:23]
    ds_read_b128 v[56:59], v125 offset:640
    s_waitcnt lgkmcnt(12)
    v_mfma_f32_16x16x32_bf16 v[8:11], v[72:75], v[76:79], v[8:11]
    ds_read_b128 v[60:63], v125 offset:1152
    s_waitcnt lgkmcnt(12)
    v_mfma_f32_16x16x32_bf16 v[12:15], v[72:75], v[80:83], v[12:15]
    ds_read_b128 v[52:55], v125 offset:1664
    s_waitcnt lgkmcnt(12)
    v_mfma_f32_16x16x32_bf16 v[16:19], v[72:75], v[84:87], v[16:19]
    ds_read_b128 v[64:67], v125 offset:192
    s_waitcnt lgkmcnt(12)
    v_mfma_f32_16x16x32_bf16 v[20:23], v[72:75], v[88:91], v[20:23]
    ds_read_b128 v[48:51], v126 offset:0
    buffer_load_dwordx4 v[152:155], v2, s[8:11], s56 offen offset:2048 sc1
    s_waitcnt lgkmcnt(12)
    v_mfma_f32_16x16x32_bf16 v[12:15], v[92:95], v[76:79], v[12:15]
    ds_read_b128 v[68:71], v126 offset:512
    v_mfma_f32_16x16x32_bf16 v[16:19], v[92:95], v[80:83], v[16:19]
    ds_read_b128 v[44:47], v126 offset:1024
    v_mfma_f32_16x16x32_bf16 v[20:23], v[92:95], v[84:87], v[20:23]
    s_waitcnt lgkmcnt(13)
    v_mfma_f32_16x16x32_bf16 v[16:19], v[96:99], v[76:79], v[16:19]
    ds_read_b128 v[72:75], v126 offset:1536
    v_mfma_f32_16x16x32_bf16 v[20:23], v[96:99], v[80:83], v[20:23]
    s_waitcnt lgkmcnt(13)
    v_mfma_f32_16x16x32_bf16 v[20:23], v[100:103], v[76:79], v[20:23]
    ds_read_b128 v[88:91], v125 offset:704
    buffer_load_dwordx4 v[156:159], v2, s[8:11], s56 offen offset:3072 sc1
    s_add_u32 s56, s56, 4096
    s_and_b32 s56, s56, 0x7fff
    s_waitcnt lgkmcnt(12)
    v_mfma_f32_16x16x32_bf16 v[8:11], v[104:107], v[108:111], v[8:11]
    ds_read_b128 v[92:95], v125 offset:1216
    s_waitcnt lgkmcnt(12)
    v_mfma_f32_16x16x32_bf16 v[12:15], v[104:107], v[112:115], v[12:15]
    ds_read_b128 v[84:87], v125 offset:1728
    s_waitcnt lgkmcnt(12)
    v_mfma_f32_16x16x32_bf16 v[16:19], v[104:107], v[116:119], v[16:19]
    ds_read_b128 v[96:99], v125 offset:0
    s_waitcnt lgkmcnt(12)
    v_mfma_f32_16x16x32_bf16 v[20:23], v[104:107], v[40:43], v[20:23]
    ds_read_b128 v[80:83], v126 offset:3776
    s_waitcnt lgkmcnt(12)
    v_mfma_f32_16x16x32_bf16 v[12:15], v[56:59], v[108:111], v[12:15]
    ds_read_b128 v[100:103], v126 offset:3264
    v_mfma_f32_16x16x32_bf16 v[16:19], v[56:59], v[112:115], v[16:19]
    ds_read_b128 v[76:79], v126 offset:2752
    buffer_load_dwordx4 v[160:163], v2, s[8:11], s56 offen offset:0 sc1
    v_mfma_f32_16x16x32_bf16 v[20:23], v[56:59], v[116:119], v[20:23]
    s_waitcnt lgkmcnt(13)
    v_mfma_f32_16x16x32_bf16 v[16:19], v[60:63], v[108:111], v[16:19]
    ds_read_b128 v[104:107], v126 offset:2240
    v_mfma_f32_16x16x32_bf16 v[20:23], v[60:63], v[112:115], v[20:23]
    s_waitcnt lgkmcnt(13)
    v_mfma_f32_16x16x32_bf16 v[20:23], v[52:55], v[108:111], v[20:23]
    ds_read_b128 v[40:43], v125 offset:512
    s_waitcnt lgkmcnt(12)
    v_mfma_f32_16x16x32_bf16 v[8:11], v[64:67], v[48:51], v[8:11]
    ds_read_b128 v[56:59], v126 offset:1728
    s_waitcnt lgkmcnt(12)
    v_mfma_f32_16x16x32_bf16 v[12:15], v[64:67], v[68:71], v[12:15]
    ds_read_b128 v[116:119], v125 offset:1024
    buffer_load_dwordx4 v[164:167], v2, s[8:11], s56 offen offset:1024 sc1
    s_waitcnt lgkmcnt(12)
    v_mfma_f32_16x16x32_bf16 v[16:19], v[64:67], v[44:47], v[16:19]
    ds_read_b128 v[60:63], v126 offset:1216
    s_waitcnt lgkmcnt(12)
    v_mfma_f32_16x16x32_bf16 v[20:23], v[64:67], v[72:75], v[20:23]
    ds_read_b128 v[112:115], v125 offset:1536
    s_waitcnt lgkmcnt(12)
    v_mfma_f32_16x16x32_bf16 v[12:15], v[88:91], v[48:51], v[12:15]
    ds_read_b128 v[52:55], v126 offset:704
    v_mfma_f32_16x16x32_bf16 v[16:19], v[88:91], v[68:71], v[16:19]
    ds_read_b128 v[108:111], v125 offset:2048
    v_mfma_f32_16x16x32_bf16 v[20:23], v[88:91], v[44:47], v[20:23]
    s_waitcnt lgkmcnt(13)
    v_mfma_f32_16x16x32_bf16 v[16:19], v[92:95], v[48:51], v[16:19]
    ds_read_b128 v[64:67], v126 offset:192
    buffer_load_dwordx4 v[168:171], v2, s[8:11], s56 offen offset:2048 sc1
    v_mfma_f32_16x16x32_bf16 v[20:23], v[92:95], v[68:71], v[20:23]
    s_waitcnt lgkmcnt(13)
    v_mfma_f32_16x16x32_bf16 v[20:23], v[84:87], v[48:51], v[20:23]
    ds_read_b128 v[72:75], v125 offset:2560
    s_waitcnt lgkmcnt(12)
    v_mfma_f32_16x16x32_bf16 v[36:39], v[96:99], v[80:83], 0
    ds_read_b128 v[88:91], v125 offset:3072
    s_waitcnt lgkmcnt(12)
    v_mfma_f32_16x16x32_bf16 v[32:35], v[96:99], v[100:103], 0
    ds_read_b128 v[44:47], v125 offset:3584
    s_waitcnt lgkmcnt(12)
    v_mfma_f32_16x16x32_bf16 v[28:31], v[96:99], v[76:79], 0
    ds_read_b128 v[92:95], v125 offset:64
    s_waitcnt lgkmcnt(12)
    v_mfma_f32_16x16x32_bf16 v[24:27], v[96:99], v[104:107], 0
    ds_read_b128 v[68:71], v126 offset:3712
    buffer_load_dwordx4 v[172:175], v2, s[8:11], s56 offen offset:3072 sc1
    s_add_u32 s56, s56, 4096
    s_and_b32 s56, s56, 0x7fff
    s_waitcnt lgkmcnt(12)
    v_mfma_f32_16x16x32_bf16 v[36:39], v[40:43], v[100:103], v[36:39]
    ds_read_b128 v[84:87], v126 offset:3200
    v_mfma_f32_16x16x32_bf16 v[32:35], v[40:43], v[76:79], v[32:35]
    ds_read_b128 v[48:51], v126 offset:2688
    v_mfma_f32_16x16x32_bf16 v[28:31], v[40:43], v[104:107], v[28:31]
    s_waitcnt lgkmcnt(13)
    v_mfma_f32_16x16x32_bf16 v[24:27], v[40:43], v[56:59], v[24:27]
    ds_read_b128 v[80:83], v126 offset:2176
    s_waitcnt lgkmcnt(8)
    ds_write_b128 v124, v[8:11] offset:0
    ds_write_b128 v124, v[12:15] offset:1280
    ds_write_b128 v124, v[16:19] offset:2560
    ds_write_b128 v124, v[20:23] offset:3840
    v_mfma_f32_16x16x32_bf16 v[36:39], v[116:119], v[76:79], v[36:39]
    ds_read_b128 v[96:99], v125 offset:576
    v_mfma_f32_16x16x32_bf16 v[32:35], v[116:119], v[104:107], v[32:35]
    ds_read_b128 v[100:103], v126 offset:1664
    buffer_load_dwordx4 v[176:179], v2, s[8:11], s56 offen offset:0 sc1
    v_mfma_f32_16x16x32_bf16 v[28:31], v[116:119], v[56:59], v[28:31]
    v_mfma_f32_16x16x32_bf16 v[24:27], v[116:119], v[60:63], v[24:27]
    v_mfma_f32_16x16x32_bf16 v[36:39], v[112:115], v[104:107], v[36:39]
    v_mfma_f32_16x16x32_bf16 v[32:35], v[112:115], v[56:59], v[32:35]
    s_waitcnt lgkmcnt(2)
    s_barrier
    v_mfma_f32_16x16x32_bf16 v[28:31], v[112:115], v[60:63], v[28:31]
    ds_read_b128 v[40:43], v125 offset:1088
    v_mfma_f32_16x16x32_bf16 v[24:27], v[112:115], v[52:55], v[24:27]
    ds_read_b128 v[76:79], v126 offset:1152
    buffer_load_dwordx4 v[180:183], v2, s[8:11], s56 offen offset:1024 sc1
    v_mfma_f32_16x16x32_bf16 v[36:39], v[108:111], v[56:59], v[36:39]
    ds_read_b128 v[116:119], v125 offset:1600
    v_mfma_f32_16x16x32_bf16 v[32:35], v[108:111], v[60:63], v[32:35]
    ds_read_b128 v[104:107], v126 offset:640
    v_mfma_f32_16x16x32_bf16 v[28:31], v[108:111], v[52:55], v[28:31]
    ds_read_b128 v[112:115], v125 offset:2112
    v_mfma_f32_16x16x32_bf16 v[24:27], v[108:111], v[64:67], v[24:27]
    ds_read_b128 v[56:59], v126 offset:128
    v_mfma_f32_16x16x32_bf16 v[36:39], v[72:75], v[60:63], v[36:39]
    ds_read_b128 v[108:111], v125 offset:2624
    v_mfma_f32_16x16x32_bf16 v[32:35], v[72:75], v[52:55], v[32:35]
    ds_read_b128 v[60:63], v125 offset:3136
    buffer_load_dwordx4 v[184:187], v2, s[8:11], s56 offen offset:2048 sc1
    v_mfma_f32_16x16x32_bf16 v[28:31], v[72:75], v[64:67], v[28:31]
    ds_read_b128 v[72:75], v125 offset:3648
    v_mfma_f32_16x16x32_bf16 v[36:39], v[88:91], v[52:55], v[36:39]
    ds_read_b128 v[52:55], v125 offset:128
    v_mfma_f32_16x16x32_bf16 v[32:35], v[88:91], v[64:67], v[32:35]
    ds_read_b128 v[88:91], v126 offset:3648
    v_mfma_f32_16x16x32_bf16 v[36:39], v[44:47], v[64:67], v[36:39]
    ds_read_b128 v[44:47], v126 offset:3136
    v_mfma_f32_16x16x32_bf16 v[36:39], v[92:95], v[68:71], v[36:39]
    v_mfma_f32_16x16x32_bf16 v[32:35], v[92:95], v[84:87], v[32:35]
    buffer_load_dwordx4 v[188:191], v2, s[8:11], s56 offen offset:3072 sc1
    s_add_u32 s56, s56, 4096
    s_and_b32 s56, s56, 0x7fff
    v_mfma_f32_16x16x32_bf16 v[28:31], v[92:95], v[48:51], v[28:31]
    v_mfma_f32_16x16x32_bf16 v[24:27], v[92:95], v[80:83], v[24:27]
    s_waitcnt lgkmcnt(13)
    v_mfma_f32_16x16x32_bf16 v[36:39], v[96:99], v[84:87], v[36:39]
    ds_read_b128 v[64:67], v126 offset:2624
    v_mfma_f32_16x16x32_bf16 v[32:35], v[96:99], v[48:51], v[32:35]
    v_mfma_f32_16x16x32_bf16 v[28:31], v[96:99], v[80:83], v[28:31]
    s_waitcnt lgkmcnt(13)
    v_mfma_f32_16x16x32_bf16 v[24:27], v[96:99], v[100:103], v[24:27]
    ds_read_b128 v[68:71], v126 offset:2112
    buffer_load_dwordx4 v[192:195], v2, s[8:11], s56 offen offset:0 sc1
    s_waitcnt lgkmcnt(13)
    v_mfma_f32_16x16x32_bf16 v[36:39], v[40:43], v[48:51], v[36:39]
    ds_read_b128 v[92:95], v125 offset:640
    v_mfma_f32_16x16x32_bf16 v[32:35], v[40:43], v[80:83], v[32:35]
    v_mfma_f32_16x16x32_bf16 v[28:31], v[40:43], v[100:103], v[28:31]
    s_waitcnt lgkmcnt(13)
    v_mfma_f32_16x16x32_bf16 v[24:27], v[40:43], v[76:79], v[24:27]
    ds_read_b128 v[84:87], v126 offset:1600
    s_waitcnt lgkmcnt(13)
    v_mfma_f32_16x16x32_bf16 v[36:39], v[116:119], v[80:83], v[36:39]
    ds_read_b128 v[96:99], v125 offset:1152
    v_mfma_f32_16x16x32_bf16 v[32:35], v[116:119], v[100:103], v[32:35]
    buffer_load_dwordx4 v[196:199], v2, s[8:11], s56 offen offset:1024 sc1
    v_mfma_f32_16x16x32_bf16 v[28:31], v[116:119], v[76:79], v[28:31]
    s_waitcnt lgkmcnt(13)
    v_mfma_f32_16x16x32_bf16 v[24:27], v[116:119], v[104:107], v[24:27]
    ds_read_b128 v[48:51], v126 offset:1088
    s_waitcnt lgkmcnt(13)
    v_mfma_f32_16x16x32_bf16 v[36:39], v[112:115], v[100:103], v[36:39]
    ds_read_b128 v[40:43], v125 offset:1664
    v_mfma_f32_16x16x32_bf16 v[32:35], v[112:115], v[76:79], v[32:35]
    v_mfma_f32_16x16x32_bf16 v[28:31], v[112:115], v[104:107], v[28:31]
    s_waitcnt lgkmcnt(13)
    v_mfma_f32_16x16x32_bf16 v[24:27], v[112:115], v[56:59], v[24:27]
    ds_read_b128 v[80:83], v126 offset:576
    buffer_load_dwordx4 v[200:203], v2, s[8:11], s56 offen offset:2048 sc1
    s_waitcnt lgkmcnt(13)
    v_mfma_f32_16x16x32_bf16 v[36:39], v[108:111], v[76:79], v[36:39]
    ds_read_b128 v[116:119], v125 offset:2176
    v_mfma_f32_16x16x32_bf16 v[32:35], v[108:111], v[104:107], v[32:35]
    v_mfma_f32_16x16x32_bf16 v[28:31], v[108:111], v[56:59], v[28:31]
    s_waitcnt lgkmcnt(13)
    v_mfma_f32_16x16x32_bf16 v[36:39], v[60:63], v[104:107], v[36:39]
    ds_read_b128 v[100:103], v126 offset:64
    v_mfma_f32_16x16x32_bf16 v[32:35], v[60:63], v[56:59], v[32:35]
    s_waitcnt lgkmcnt(13)
    v_mfma_f32_16x16x32_bf16 v[36:39], v[72:75], v[56:59], v[36:39]
    ds_read_b128 v[112:115], v125 offset:2688
    buffer_load_dwordx4 v[204:207], v2, s[8:11], s56 offen offset:3072 sc1
    s_add_u32 s56, s56, 4096
    s_and_b32 s56, s56, 0x7fff
    s_waitcnt lgkmcnt(12)
    v_mfma_f32_16x16x32_bf16 v[36:39], v[52:55], v[88:91], v[36:39]
    ds_read_b128 v[76:79], v125 offset:3200
    s_waitcnt lgkmcnt(12)
    v_mfma_f32_16x16x32_bf16 v[32:35], v[52:55], v[44:47], v[32:35]
    ds_read_b128 v[108:111], v125 offset:3712
    s_waitcnt lgkmcnt(12)
    v_mfma_f32_16x16x32_bf16 v[28:31], v[52:55], v[64:67], v[28:31]
    ds_read_b128 v[104:107], v125 offset:192
    s_waitcnt lgkmcnt(12)
    v_mfma_f32_16x16x32_bf16 v[24:27], v[52:55], v[68:71], v[24:27]
    ds_read_b128 v[60:63], v126 offset:3584
    s_waitcnt lgkmcnt(12)
    v_mfma_f32_16x16x32_bf16 v[36:39], v[92:95], v[44:47], v[36:39]
    ds_read_b128 v[72:75], v126 offset:3072
    v_mfma_f32_16x16x32_bf16 v[32:35], v[92:95], v[64:67], v[32:35]
    ds_read_b128 v[56:59], v126 offset:2560
    buffer_load_dwordx4 v[208:211], v2, s[8:11], s56 offen offset:0 sc1
    v_mfma_f32_16x16x32_bf16 v[28:31], v[92:95], v[68:71], v[28:31]
    s_waitcnt lgkmcnt(13)
    v_mfma_f32_16x16x32_bf16 v[24:27], v[92:95], v[84:87], v[24:27]
    ds_read_b128 v[88:91], v126 offset:2048
    s_waitcnt lgkmcnt(13)
    v_mfma_f32_16x16x32_bf16 v[36:39], v[96:99], v[64:67], v[36:39]
    ds_read_b128 v[52:55], v125 offset:704
    v_mfma_f32_16x16x32_bf16 v[32:35], v[96:99], v[68:71], v[32:35]
    v_mfma_f32_16x16x32_bf16 v[28:31], v[96:99], v[84:87], v[28:31]
    s_waitcnt lgkmcnt(13)
    v_mfma_f32_16x16x32_bf16 v[24:27], v[96:99], v[48:51], v[24:27]
    ds_read_b128 v[44:47], v126 offset:1536
    buffer_load_dwordx4 v[212:215], v2, s[8:11], s56 offen offset:1024 sc1
    s_waitcnt lgkmcnt(13)
    v_mfma_f32_16x16x32_bf16 v[36:39], v[40:43], v[68:71], v[36:39]
    ds_read_b128 v[92:95], v125 offset:1216
    v_mfma_f32_16x16x32_bf16 v[32:35], v[40:43], v[84:87], v[32:35]
    v_mfma_f32_16x16x32_bf16 v[28:31], v[40:43], v[48:51], v[28:31]
    s_waitcnt lgkmcnt(13)
    v_mfma_f32_16x16x32_bf16 v[24:27], v[40:43], v[80:83], v[24:27]
    ds_read_b128 v[64:67], v126 offset:1024
    s_waitcnt lgkmcnt(13)
    v_mfma_f32_16x16x32_bf16 v[36:39], v[116:119], v[84:87], v[36:39]
    ds_read_b128 v[96:99], v125 offset:1728
    v_mfma_f32_16x16x32_bf16 v[32:35], v[116:119], v[48:51], v[32:35]
    buffer_load_dwordx4 v[216:219], v2, s[8:11], s56 offen offset:2048 sc1
    v_mfma_f32_16x16x32_bf16 v[28:31], v[116:119], v[80:83], v[28:31]
    s_waitcnt lgkmcnt(13)
    v_mfma_f32_16x16x32_bf16 v[24:27], v[116:119], v[100:103], v[24:27]
    ds_read_b128 v[68:71], v126 offset:512
    s_waitcnt lgkmcnt(13)
    v_mfma_f32_16x16x32_bf16 v[36:39], v[112:115], v[48:51], v[36:39]
    ds_read_b128 v[40:43], v125 offset:2240
    v_mfma_f32_16x16x32_bf16 v[32:35], v[112:115], v[80:83], v[32:35]
    v_mfma_f32_16x16x32_bf16 v[28:31], v[112:115], v[100:103], v[28:31]
    s_waitcnt lgkmcnt(13)
    v_mfma_f32_16x16x32_bf16 v[36:39], v[76:79], v[80:83], v[36:39]
    ds_read_b128 v[84:87], v126 offset:0
    buffer_load_dwordx4 v[220:223], v2, s[8:11], s56 offen offset:3072 sc1
    s_add_u32 s56, s56, 4096
    s_and_b32 s56, s56, 0x7fff
    v_mfma_f32_16x16x32_bf16 v[32:35], v[76:79], v[100:103], v[32:35]
    s_waitcnt lgkmcnt(13)
    v_mfma_f32_16x16x32_bf16 v[36:39], v[108:111], v[100:103], v[36:39]
    ds_read_b128 v[116:119], v125 offset:2752
    s_waitcnt lgkmcnt(12)
    v_mfma_f32_16x16x32_bf16 v[36:39], v[104:107], v[60:63], v[36:39]
    ds_read_b128 v[48:51], v125 offset:3264
    s_waitcnt lgkmcnt(12)
    v_mfma_f32_16x16x32_bf16 v[32:35], v[104:107], v[72:75], v[32:35]
    ds_read_b128 v[112:115], v125 offset:3776
    s_waitcnt lgkmcnt(12)
    v_mfma_f32_16x16x32_bf16 v[28:31], v[104:107], v[56:59], v[28:31]
    s_waitcnt lgkmcnt(11)
    v_mfma_f32_16x16x32_bf16 v[24:27], v[104:107], v[88:91], v[24:27]
    s_waitcnt lgkmcnt(10)
    v_mfma_f32_16x16x32_bf16 v[36:39], v[52:55], v[72:75], v[36:39]
    v_mfma_f32_16x16x32_bf16 v[32:35], v[52:55], v[56:59], v[32:35]
    v_mfma_f32_16x16x32_bf16 v[28:31], v[52:55], v[88:91], v[28:31]
    s_waitcnt lgkmcnt(9)
    v_mfma_f32_16x16x32_bf16 v[24:27], v[52:55], v[44:47], v[24:27]
    s_waitcnt lgkmcnt(8)
    v_mfma_f32_16x16x32_bf16 v[36:39], v[92:95], v[56:59], v[36:39]
    v_mfma_f32_16x16x32_bf16 v[32:35], v[92:95], v[88:91], v[32:35]
    v_mfma_f32_16x16x32_bf16 v[28:31], v[92:95], v[44:47], v[28:31]
    s_waitcnt lgkmcnt(7)
    v_mfma_f32_16x16x32_bf16 v[24:27], v[92:95], v[64:67], v[24:27]
    s_waitcnt lgkmcnt(6)
    v_mfma_f32_16x16x32_bf16 v[36:39], v[96:99], v[88:91], v[36:39]
    v_mfma_f32_16x16x32_bf16 v[32:35], v[96:99], v[44:47], v[32:35]
    v_mfma_f32_16x16x32_bf16 v[28:31], v[96:99], v[64:67], v[28:31]
    s_waitcnt lgkmcnt(5)
    v_mfma_f32_16x16x32_bf16 v[24:27], v[96:99], v[68:71], v[24:27]
    s_waitcnt lgkmcnt(4)
    v_mfma_f32_16x16x32_bf16 v[36:39], v[40:43], v[44:47], v[36:39]
    v_mfma_f32_16x16x32_bf16 v[32:35], v[40:43], v[64:67], v[32:35]
    v_mfma_f32_16x16x32_bf16 v[28:31], v[40:43], v[68:71], v[28:31]
    s_waitcnt lgkmcnt(3)
    v_mfma_f32_16x16x32_bf16 v[24:27], v[40:43], v[84:87], v[24:27]
    s_waitcnt lgkmcnt(2)
    v_mfma_f32_16x16x32_bf16 v[36:39], v[116:119], v[64:67], v[36:39]
    v_mfma_f32_16x16x32_bf16 v[32:35], v[116:119], v[68:71], v[32:35]
    v_mfma_f32_16x16x32_bf16 v[28:31], v[116:119], v[84:87], v[28:31]
    s_waitcnt lgkmcnt(1)
    v_mfma_f32_16x16x32_bf16 v[36:39], v[48:51], v[68:71], v[36:39]
    v_mfma_f32_16x16x32_bf16 v[32:35], v[48:51], v[84:87], v[32:35]
    s_waitcnt lgkmcnt(0)
    v_mfma_f32_16x16x32_bf16 v[36:39], v[112:115], v[84:87], v[36:39]
    s_nop 15
    ds_write_b128 v124, v[24:27] offset:20608
    ds_write_b128 v124, v[28:31] offset:21888
    ds_write_b128 v124, v[32:35] offset:23168
    ds_write_b128 v124, v[36:39] offset:24448
    s_waitcnt lgkmcnt(0)
    s_barrier
    s_setprio 0
    v_readfirstlane_b32 s31, v5
    v_and_b32 v7, 15, v1
    v_lshrrev_b32 v8, 2, v7
    v_and_b32 v9, 3, v7
    v_lshlrev_b32 v9, 3, v9
    v_and_b32 v5, 31, v1
    v_lshlrev_b32 v10, 4, v5
    v_add_u32 v10, 136384, v10
    s_mul_i32 s61, s52, 56
    s_add_u32 s61, s61, s54
    s_lshl_b32 s61, s61, 11
    s_add_u32 s61, s61, 0x800000
    s_lshl_b32 s34, s53, 7
    v_lshl_add_u32 v15, v5, 2, s34
    s_lshl_b32 s34, s54, 6
    v_lshl_add_u32 v5, v5, 1, s34
    global_load_dword v11, v15, s[48:49]
    global_load_short_d16_hi v13, v5, s[100:101]
    v_lshrrev_b32 v4, 5, v1
    v_lshl_add_u32 v6, v4, 3, v8
    v_lshl_add_u32 v6, v6, 6, v9
    v_and_b32 v5, 16, v1
    v_lshl_add_u32 v6, v5, 1, v6
    v_and_b32 v5, 31, v1
    v_lshlrev_b32 v5, 5, v5
    v_lshl_add_u32 v14, v4, 4, v5
    s_lshl_b32 s60, s54, 10
    v_and_b32 v4, 3, v1
    v_lshlrev_b32 v4, 3, v4
    v_lshrrev_b32 v4, v4, s31
    v_bfe_u32 v5, v4, 0, 1
    v_lshlrev_b32 v5, 15, v5
    v_lshrrev_b32 v124, 1, v4
    v_lshl_or_b32 v124, v124, 31, v5
    v_bfe_u32 v5, v4, 2, 1
    v_lshlrev_b32 v5, 15, v5
    v_lshrrev_b32 v125, 3, v4
    v_lshl_or_b32 v125, v125, 31, v5
    v_bfe_u32 v5, v4, 4, 1
    v_lshlrev_b32 v5, 15, v5
    v_lshrrev_b32 v126, 5, v4
    v_lshl_or_b32 v126, v126, 31, v5
    v_bfe_u32 v5, v4, 6, 1
    v_lshlrev_b32 v5, 15, v5
    v_lshrrev_b32 v127, 7, v4
    v_lshl_or_b32 v127, v127, 31, v5
    buffer_load_dwordx4 v[224:227], v2, s[8:11], s56 offen offset:0 sc1
    buffer_load_dwordx4 v[228:231], v2, s[8:11], s56 offen offset:1024 sc1
    buffer_load_dwordx4 v[232:235], v2, s[8:11], s56 offen offset:2048 sc1
    buffer_load_dwordx4 v[236:239], v2, s[8:11], s56 offen offset:3072 sc1
    s_add_u32 s56, s56, 4096
    s_and_b32 s56, s56, 0x7fff
    buffer_load_dwordx4 v[240:243], v2, s[8:11], s56 offen offset:0 sc1
    buffer_load_dwordx4 v[244:247], v2, s[8:11], s56 offen offset:1024 sc1
    buffer_load_dwordx4 v[248:251], v2, s[8:11], s56 offen offset:2048 sc1
    buffer_load_dwordx4 v[252:255], v2, s[8:11], s56 offen offset:3072 sc1
    v_cmp_gt_u32 s[16:17], 32, v1
    v_add_u32 v7, s46, v2
    s_waitcnt lgkmcnt(0)
    s_barrier
    buffer_load_dwordx4 v[120:123], v14, s[36:39], s60 offen offset:0 sc1
    buffer_load_dwordx4 v[64:67], v2, s[12:15], s57 offen offset:0 sc1
    buffer_load_dwordx4 v[68:71], v2, s[12:15], s57 offen offset:1024 sc1
    buffer_load_dwordx4 v[72:75], v2, s[12:15], s57 offen offset:2048 sc1
    buffer_load_dwordx4 v[76:79], v2, s[12:15], s57 offen offset:3072 sc1
    s_add_u32 s57, s57, 4096
    buffer_load_dwordx4 v[80:83], v2, s[12:15], s57 offen offset:0 sc1
    buffer_load_dwordx4 v[84:87], v2, s[12:15], s57 offen offset:1024 sc1
    buffer_load_dwordx4 v[88:91], v2, s[12:15], s57 offen offset:2048 sc1
    buffer_load_dwordx4 v[92:95], v2, s[12:15], s57 offen offset:3072 sc1
    s_add_u32 s57, s57, 4096
    buffer_load_dwordx4 v[96:99], v2, s[12:15], s57 offen offset:0 sc1
    buffer_load_dwordx4 v[100:103], v2, s[12:15], s57 offen offset:1024 sc1
    ds_read_b64_tr_b16 v[32:33], v6 offset:33280
    ds_read_b64_tr_b16 v[34:35], v6 offset:33536
    ds_read_b64_tr_b16 v[36:37], v6 offset:34304
    ds_read_b64_tr_b16 v[38:39], v6 offset:34560
    ds_read_b64_tr_b16 v[40:41], v6 offset:35328
    ds_read_b64_tr_b16 v[42:43], v6 offset:35584
    s_waitcnt vmcnt(41)
    s_waitcnt lgkmcnt(4)
    v_mfma_f32_32x32x16_bf16 v[16:31], v[128:131], v[32:35], 0
    ds_read_b64_tr_b16 v[44:45], v6 offset:36352
    ds_read_b64_tr_b16 v[46:47], v6 offset:36608
    s_waitcnt lgkmcnt(4)
    v_mfma_f32_32x32x16_bf16 v[16:31], v[132:135], v[36:39], v[16:31]
    ds_read_b64_tr_b16 v[32:33], v6 offset:37376
    ds_read_b64_tr_b16 v[34:35], v6 offset:37632
    buffer_load_dwordx4 v[104:107], v2, s[12:15], s57 offen offset:2048 sc1
    s_waitcnt lgkmcnt(4)
    v_mfma_f32_32x32x16_bf16 v[16:31], v[136:139], v[40:43], v[16:31]
    ds_read_b64_tr_b16 v[36:37], v6 offset:38400
    ds_read_b64_tr_b16 v[38:39], v6 offset:38656
    s_waitcnt lgkmcnt(4)
    v_mfma_f32_32x32x16_bf16 v[16:31], v[140:143], v[44:47], v[16:31]
    ds_read_b64_tr_b16 v[40:41], v6 offset:39424
    ds_read_b64_tr_b16 v[42:43], v6 offset:39680
    buffer_load_dwordx4 v[108:111], v2, s[12:15], s57 offen offset:3072 sc1
    s_add_u32 s57, s57, 4096
    s_waitcnt vmcnt(39)
    s_waitcnt lgkmcnt(4)
    v_mfma_f32_32x32x16_bf16 v[16:31], v[144:147], v[32:35], v[16:31]
    ds_read_b64_tr_b16 v[44:45], v6 offset:40448
    ds_read_b64_tr_b16 v[46:47], v6 offset:40704
    s_waitcnt lgkmcnt(4)
    v_mfma_f32_32x32x16_bf16 v[16:31], v[148:151], v[36:39], v[16:31]
    ds_read_b64_tr_b16 v[32:33], v6 offset:41472
    ds_read_b64_tr_b16 v[34:35], v6 offset:41728
    buffer_load_dwordx4 v[112:115], v2, s[12:15], s57 offen offset:0 sc1
    s_waitcnt lgkmcnt(4)
    v_mfma_f32_32x32x16_bf16 v[16:31], v[152:155], v[40:43], v[16:31]
    ds_read_b64_tr_b16 v[36:37], v6 offset:42496
    ds_read_b64_tr_b16 v[38:39], v6 offset:42752
    s_waitcnt lgkmcnt(4)
    v_mfma_f32_32x32x16_bf16 v[16:31], v[156:159], v[44:47], v[16:31]
    ds_read_b64_tr_b16 v[40:41], v6 offset:43520
    ds_read_b64_tr_b16 v[42:43], v6 offset:43776
    buffer_load_dwordx4 v[116:119], v2, s[12:15], s57 offen offset:1024 sc1
    s_waitcnt vmcnt(37)
    s_waitcnt lgkmcnt(4)
    v_mfma_f32_32x32x16_bf16 v[16:31], v[160:163], v[32:35], v[16:31]
    ds_read_b64_tr_b16 v[44:45], v6 offset:44544
    ds_read_b64_tr_b16 v[46:47], v6 offset:44800
    s_waitcnt lgkmcnt(4)
    v_mfma_f32_32x32x16_bf16 v[16:31], v[164:167], v[36:39], v[16:31]
    ds_read_b64_tr_b16 v[32:33], v6 offset:45568
    ds_read_b64_tr_b16 v[34:35], v6 offset:45824
    s_add_u32 s47, s46, 12288
    s_mov_b32 m0, s47
    s_nop 0
    buffer_load_dwordx4 v2, s[12:15], s57 offen offset:2048 sc1 lds
    s_waitcnt lgkmcnt(4)
    v_mfma_f32_32x32x16_bf16 v[16:31], v[168:171], v[40:43], v[16:31]
    ds_read_b64_tr_b16 v[36:37], v6 offset:46592
    ds_read_b64_tr_b16 v[38:39], v6 offset:46848
    s_waitcnt lgkmcnt(4)
    v_mfma_f32_32x32x16_bf16 v[16:31], v[172:175], v[44:47], v[16:31]
    ds_read_b64_tr_b16 v[40:41], v6 offset:47616
    ds_read_b64_tr_b16 v[42:43], v6 offset:47872
    buffer_load_dwordx4 v2, s[12:15], s57 offen offset:3072 sc1 lds
    s_add_u32 s57, s57, 4096
    s_waitcnt vmcnt(35)
    s_waitcnt lgkmcnt(4)
    v_mfma_f32_32x32x16_bf16 v[16:31], v[176:179], v[32:35], v[16:31]
    ds_read_b64_tr_b16 v[44:45], v6 offset:48640
    ds_read_b64_tr_b16 v[46:47], v6 offset:48896
    s_waitcnt lgkmcnt(4)
    v_mfma_f32_32x32x16_bf16 v[16:31], v[180:183], v[36:39], v[16:31]
    ds_read_b64_tr_b16 v[32:33], v6 offset:49664
    ds_read_b64_tr_b16 v[34:35], v6 offset:49920
    s_add_u32 s47, s46, 16384
    s_mov_b32 m0, s47
    s_nop 0
    buffer_load_dwordx4 v2, s[12:15], s57 offen offset:0 sc1 lds
    s_waitcnt lgkmcnt(4)
    v_mfma_f32_32x32x16_bf16 v[16:31], v[184:187], v[40:43], v[16:31]
    ds_read_b64_tr_b16 v[36:37], v6 offset:50688
    ds_read_b64_tr_b16 v[38:39], v6 offset:50944
    s_waitcnt lgkmcnt(4)
    v_mfma_f32_32x32x16_bf16 v[16:31], v[188:191], v[44:47], v[16:31]
    ds_read_b64_tr_b16 v[40:41], v6 offset:51712
    ds_read_b64_tr_b16 v[42:43], v6 offset:51968
    buffer_load_dwordx4 v2, s[12:15], s57 offen offset:1024 sc1 lds
    s_waitcnt vmcnt(33)
    s_waitcnt lgkmcnt(4)
    v_mfma_f32_32x32x16_bf16 v[16:31], v[192:195], v[32:35], v[16:31]
    ds_read_b64_tr_b16 v[44:45], v6 offset:52736
    ds_read_b64_tr_b16 v[46:47], v6 offset:52992
    s_waitcnt lgkmcnt(4)
    v_mfma_f32_32x32x16_bf16 v[16:31], v[196:199], v[36:39], v[16:31]
    ds_read_b64_tr_b16 v[32:33], v6 offset:53760
    ds_read_b64_tr_b16 v[34:35], v6 offset:54016
    buffer_load_dwordx4 v2, s[12:15], s57 offen offset:2048 sc1 lds
    s_waitcnt lgkmcnt(4)
    v_mfma_f32_32x32x16_bf16 v[16:31], v[200:203], v[40:43], v[16:31]
    ds_read_b64_tr_b16 v[36:37], v6 offset:54784
    ds_read_b64_tr_b16 v[38:39], v6 offset:55040
    s_waitcnt lgkmcnt(4)
    v_mfma_f32_32x32x16_bf16 v[16:31], v[204:207], v[44:47], v[16:31]
    ds_read_b64_tr_b16 v[40:41], v6 offset:55808
    ds_read_b64_tr_b16 v[42:43], v6 offset:56064
    buffer_load_dwordx4 v2, s[12:15], s57 offen offset:3072 sc1 lds
    s_add_u32 s57, s57, 4096
    s_waitcnt vmcnt(31)
    s_waitcnt lgkmcnt(4)
    v_mfma_f32_32x32x16_bf16 v[16:31], v[208:211], v[32:35], v[16:31]
    ds_read_b64_tr_b16 v[44:45], v6 offset:56832
    ds_read_b64_tr_b16 v[46:47], v6 offset:57088
    s_waitcnt lgkmcnt(4)
    v_mfma_f32_32x32x16_bf16 v[16:31], v[212:215], v[36:39], v[16:31]
    ds_read_b64_tr_b16 v[32:33], v6 offset:57856
    ds_read_b64_tr_b16 v[34:35], v6 offset:58112
    s_add_u32 s47, s46, 20480
    s_mov_b32 m0, s47
    s_nop 0
    buffer_load_dwordx4 v2, s[12:15], s57 offen offset:0 sc1 lds
    s_waitcnt lgkmcnt(4)
    v_mfma_f32_32x32x16_bf16 v[16:31], v[216:219], v[40:43], v[16:31]
    ds_read_b64_tr_b16 v[36:37], v6 offset:58880
    ds_read_b64_tr_b16 v[38:39], v6 offset:59136
    s_waitcnt lgkmcnt(4)
    v_mfma_f32_32x32x16_bf16 v[16:31], v[220:223], v[44:47], v[16:31]
    ds_read_b64_tr_b16 v[40:41], v6 offset:59904
    ds_read_b64_tr_b16 v[42:43], v6 offset:60160
    buffer_load_dwordx4 v2, s[12:15], s57 offen offset:1024 sc1 lds
    s_waitcnt vmcnt(27)
    s_waitcnt lgkmcnt(4)
    v_mfma_f32_32x32x16_bf16 v[16:31], v[224:227], v[32:35], v[16:31]
    ds_read_b64_tr_b16 v[44:45], v6 offset:60928
    ds_read_b64_tr_b16 v[46:47], v6 offset:61184
    s_waitcnt lgkmcnt(4)
    v_mfma_f32_32x32x16_bf16 v[16:31], v[228:231], v[36:39], v[16:31]
    ds_read_b64_tr_b16 v[32:33], v6 offset:61952
    ds_read_b64_tr_b16 v[34:35], v6 offset:62208
    s_waitcnt lgkmcnt(4)
    v_mfma_f32_32x32x16_bf16 v[16:31], v[232:235], v[40:43], v[16:31]
    ds_read_b64_tr_b16 v[36:37], v6 offset:62976
    ds_read_b64_tr_b16 v[38:39], v6 offset:63232
    s_waitcnt lgkmcnt(4)
    v_mfma_f32_32x32x16_bf16 v[16:31], v[236:239], v[44:47], v[16:31]
    ds_read_b64_tr_b16 v[40:41], v6 offset:64000
    ds_read_b64_tr_b16 v[42:43], v6 offset:64256
    s_waitcnt vmcnt(23)
    s_waitcnt lgkmcnt(4)
    v_mfma_f32_32x32x16_bf16 v[16:31], v[240:243], v[32:35], v[16:31]
    ds_read_b64_tr_b16 v[44:45], v6 offset:65024
    ds_read_b64_tr_b16 v[46:47], v6 offset:65280
    s_waitcnt lgkmcnt(4)
    v_mfma_f32_32x32x16_bf16 v[16:31], v[244:247], v[36:39], v[16:31]
    s_waitcnt lgkmcnt(2)
    v_mfma_f32_32x32x16_bf16 v[16:31], v[248:251], v[40:43], v[16:31]
    s_waitcnt lgkmcnt(0)
    v_mfma_f32_32x32x16_bf16 v[16:31], v[252:255], v[44:47], v[16:31]
    s_waitcnt vmcnt(22)
    v_add_f32 v122, v120, v122
    v_add_f32 v123, v121, v123
    v_add_f32 v123, v122, v123
    v_cvt_pk_bf16_f32 v14, v123, v123
    v_lshlrev_b32 v14, 16, v14
    v_sub_f32 v123, v123, v14
    v_cndmask_b32 v13, 0, v13, s[16:17]
    v_cvt_pk_bf16_f32 v15, v123, v123
    v_lshlrev_b32 v15, 16, v15
    v_sub_f32 v123, v123, v15
    v_cvt_pk_bf16_f32 v12, v14, v15
    v_mov_b32 v14, 0
    v_mov_b32 v15, 0
    v_cvt_pk_bf16_f32 v13, v123, v13
    s_barrier
    s_setprio 3
    s_mov_b32 s32, 0
    v_mov_b32 v5, 136368
sequential_preLN__ssm_conv_s4__dense_activation_squared_relu__prompt_kernel_sw9:
    ds_read_b32 v46, v5
    ds_read_b64 v[44:45], v10 offset:0
    ds_read_b32 v4, v10 offset:8
    s_add_u32 s32, s32, 1
    s_waitcnt lgkmcnt(0)
    v_cmp_gt_u32 vcc, 1, v46
    s_cmp_gt_u32 s32, 600000
    s_cbranch_scc1 sequential_preLN__ssm_conv_s4__dense_activation_squared_relu__prompt_kernel_sw9x
    s_cbranch_vccnz sequential_preLN__ssm_conv_s4__dense_activation_squared_relu__prompt_kernel_sw9
sequential_preLN__ssm_conv_s4__dense_activation_squared_relu__prompt_kernel_sw9x:
    v_mov_b32 v46, 0
    v_mov_b32 v47, 0
    s_nop 1
    v_mfma_f32_32x32x16_bf16 v[16:31], v[12:15], v[44:47], v[16:31]
    s_nop 15
    s_nop 7
    v_mul_f32 v16, v16, v4
    v_mul_f32 v17, v17, v4
    v_mul_f32 v18, v18, v4
    v_mul_f32 v19, v19, v4
    v_mul_f32 v20, v20, v4
    v_mul_f32 v21, v21, v4
    v_mul_f32 v22, v22, v4
    v_mul_f32 v23, v23, v4
    v_max_f32 v16, 0, v16
    v_max_f32 v17, 0, v17
    v_max_f32 v18, 0, v18
    v_max_f32 v19, 0, v19
    v_max_f32 v20, 0, v20
    v_max_f32 v21, 0, v21
    v_max_f32 v22, 0, v22
    v_max_f32 v23, 0, v23
    v_mul_f32 v16, v16, v16
    v_mul_f32 v17, v17, v17
    v_mul_f32 v18, v18, v18
    v_mul_f32 v19, v19, v19
    v_mul_f32 v20, v20, v20
    v_mul_f32 v21, v21, v21
    v_mul_f32 v22, v22, v22
    v_mul_f32 v23, v23, v23
    v_cvt_pk_bf16_f32 v48, v16, v17
    v_cvt_pk_bf16_f32 v49, v18, v19
    v_cvt_pk_bf16_f32 v50, v20, v21
    v_cvt_pk_bf16_f32 v51, v22, v23
    v_or_b32 v48, v48, v124
    v_or_b32 v49, v49, v125
    v_or_b32 v50, v50, v126
    v_or_b32 v51, v51, v127
    buffer_store_dwordx4 v[48:51], v2, s[36:39], s61 offen offset:0 sc1
    v_mul_f32 v24, v24, v4
    v_mul_f32 v25, v25, v4
    v_mul_f32 v26, v26, v4
    v_mul_f32 v27, v27, v4
    v_mul_f32 v28, v28, v4
    v_mul_f32 v29, v29, v4
    v_mul_f32 v30, v30, v4
    v_mul_f32 v31, v31, v4
    v_max_f32 v24, 0, v24
    v_max_f32 v25, 0, v25
    v_max_f32 v26, 0, v26
    v_max_f32 v27, 0, v27
    v_max_f32 v28, 0, v28
    v_max_f32 v29, 0, v29
    v_max_f32 v30, 0, v30
    v_max_f32 v31, 0, v31
    v_mul_f32 v24, v24, v24
    v_mul_f32 v25, v25, v25
    v_mul_f32 v26, v26, v26
    v_mul_f32 v27, v27, v27
    v_mul_f32 v28, v28, v28
    v_mul_f32 v29, v29, v29
    v_mul_f32 v30, v30, v30
    v_mul_f32 v31, v31, v31
    v_cvt_pk_bf16_f32 v52, v24, v25
    v_cvt_pk_bf16_f32 v53, v26, v27
    v_cvt_pk_bf16_f32 v54, v28, v29
    v_cvt_pk_bf16_f32 v55, v30, v31
    v_or_b32 v52, v52, v124
    v_or_b32 v53, v53, v125
    v_or_b32 v54, v54, v126
    v_or_b32 v55, v55, v127
    buffer_store_dwordx4 v[52:55], v2, s[36:39], s61 offen offset:1024 sc1
    s_setprio 0
    s_add_u32 s61, s61, 0x380000
    s_add_u32 s47, s44, 20480
    s_mov_b32 m0, s47
    s_nop 0
    buffer_load_dwordx4 v2, s[12:15], s57 offen offset:2048 sc1 lds
    buffer_load_dwordx4 v2, s[12:15], s57 offen offset:3072 sc1 lds
    s_add_u32 s57, s57, 4096
    s_add_u32 s47, s44, 24576
    s_mov_b32 m0, s47
    s_nop 0
    buffer_load_dwordx4 v2, s[12:15], s57 offen offset:0 sc1 lds
    buffer_load_dwordx4 v2, s[12:15], s57 offen offset:1024 sc1 lds
    buffer_load_dwordx4 v2, s[12:15], s57 offen offset:2048 sc1 lds
    buffer_load_dwordx4 v2, s[12:15], s57 offen offset:3072 sc1 lds
    s_add_u32 s57, s57, 4096
    v_add_u32 v3, s44, v2
    ds_read_b64_tr_b16 v[32:33], v6 offset:0
    ds_read_b64_tr_b16 v[34:35], v6 offset:256
    ds_read_b64_tr_b16 v[36:37], v6 offset:1024
    ds_read_b64_tr_b16 v[38:39], v6 offset:1280
    ds_read_b64_tr_b16 v[40:41], v6 offset:2048
    ds_read_b64_tr_b16 v[42:43], v6 offset:2304
    s_waitcnt lgkmcnt(4)
    v_mfma_f32_32x32x16_bf16 v[16:31], v[128:131], v[32:35], 0
    ds_read_b64_tr_b16 v[44:45], v6 offset:3072
    ds_read_b64_tr_b16 v[46:47], v6 offset:3328
    s_waitcnt lgkmcnt(4)
    v_mfma_f32_32x32x16_bf16 v[16:31], v[132:135], v[36:39], v[16:31]
    ds_read_b64_tr_b16 v[32:33], v6 offset:4096
    ds_read_b64_tr_b16 v[34:35], v6 offset:4352
    s_waitcnt lgkmcnt(4)
    v_mfma_f32_32x32x16_bf16 v[16:31], v[136:139], v[40:43], v[16:31]
    ds_read_b64_tr_b16 v[36:37], v6 offset:5120
    ds_read_b64_tr_b16 v[38:39], v6 offset:5376
    s_waitcnt lgkmcnt(4)
    v_mfma_f32_32x32x16_bf16 v[16:31], v[140:143], v[44:47], v[16:31]
    ds_read_b64_tr_b16 v[40:41], v6 offset:6144
    ds_read_b64_tr_b16 v[42:43], v6 offset:6400
    s_waitcnt lgkmcnt(4)
    v_mfma_f32_32x32x16_bf16 v[16:31], v[144:147], v[32:35], v[16:31]
    ds_read_b64_tr_b16 v[44:45], v6 offset:7168
    ds_read_b64_tr_b16 v[46:47], v6 offset:7424
    s_waitcnt lgkmcnt(4)
    v_mfma_f32_32x32x16_bf16 v[16:31], v[148:151], v[36:39], v[16:31]
    ds_read_b64_tr_b16 v[32:33], v6 offset:8192
    ds_read_b64_tr_b16 v[34:35], v6 offset:8448
    s_waitcnt lgkmcnt(4)
    v_mfma_f32_32x32x16_bf16 v[16:31], v[152:155], v[40:43], v[16:31]
    ds_read_b64_tr_b16 v[36:37], v6 offset:9216
    ds_read_b64_tr_b16 v[38:39], v6 offset:9472
    s_waitcnt lgkmcnt(4)
    v_mfma_f32_32x32x16_bf16 v[16:31], v[156:159], v[44:47], v[16:31]
    ds_read_b64_tr_b16 v[40:41], v6 offset:10240
    ds_read_b64_tr_b16 v[42:43], v6 offset:10496
    s_waitcnt lgkmcnt(4)
    v_mfma_f32_32x32x16_bf16 v[16:31], v[160:163], v[32:35], v[16:31]
    ds_read_b64_tr_b16 v[44:45], v6 offset:11264
    ds_read_b64_tr_b16 v[46:47], v6 offset:11520
    s_waitcnt lgkmcnt(4)
    v_mfma_f32_32x32x16_bf16 v[16:31], v[164:167], v[36:39], v[16:31]
    ds_read_b64_tr_b16 v[32:33], v6 offset:12288
    ds_read_b64_tr_b16 v[34:35], v6 offset:12544
    s_waitcnt lgkmcnt(4)
    v_mfma_f32_32x32x16_bf16 v[16:31], v[168:171], v[40:43], v[16:31]
    ds_read_b64_tr_b16 v[36:37], v6 offset:13312
    ds_read_b64_tr_b16 v[38:39], v6 offset:13568
    s_waitcnt lgkmcnt(4)
    v_mfma_f32_32x32x16_bf16 v[16:31], v[172:175], v[44:47], v[16:31]
    ds_read_b64_tr_b16 v[40:41], v6 offset:14336
    ds_read_b64_tr_b16 v[42:43], v6 offset:14592
    s_waitcnt lgkmcnt(4)
    v_mfma_f32_32x32x16_bf16 v[16:31], v[176:179], v[32:35], v[16:31]
    ds_read_b64_tr_b16 v[44:45], v6 offset:15360
    ds_read_b64_tr_b16 v[46:47], v6 offset:15616
    s_waitcnt lgkmcnt(4)
    v_mfma_f32_32x32x16_bf16 v[16:31], v[180:183], v[36:39], v[16:31]
    ds_read_b64_tr_b16 v[32:33], v6 offset:16384
    ds_read_b64_tr_b16 v[34:35], v6 offset:16640
    s_waitcnt lgkmcnt(4)
    v_mfma_f32_32x32x16_bf16 v[16:31], v[184:187], v[40:43], v[16:31]
    ds_read_b64_tr_b16 v[36:37], v6 offset:17408
    ds_read_b64_tr_b16 v[38:39], v6 offset:17664
    s_waitcnt lgkmcnt(4)
    v_mfma_f32_32x32x16_bf16 v[16:31], v[188:191], v[44:47], v[16:31]
    ds_read_b64_tr_b16 v[40:41], v6 offset:18432
    ds_read_b64_tr_b16 v[42:43], v6 offset:18688
    s_waitcnt lgkmcnt(4)
    v_mfma_f32_32x32x16_bf16 v[16:31], v[192:195], v[32:35], v[16:31]
    ds_read_b64_tr_b16 v[44:45], v6 offset:19456
    ds_read_b64_tr_b16 v[46:47], v6 offset:19712
    s_waitcnt lgkmcnt(4)
    v_mfma_f32_32x32x16_bf16 v[16:31], v[196:199], v[36:39], v[16:31]
    ds_read_b64_tr_b16 v[32:33], v6 offset:20480
    ds_read_b64_tr_b16 v[34:35], v6 offset:20736
    s_waitcnt lgkmcnt(4)
    v_mfma_f32_32x32x16_bf16 v[16:31], v[200:203], v[40:43], v[16:31]
    ds_read_b64_tr_b16 v[36:37], v6 offset:21504
    ds_read_b64_tr_b16 v[38:39], v6 offset:21760
    s_waitcnt vmcnt(15)
    ds_read_b128 v[128:131], v7 offset:14336
    s_waitcnt lgkmcnt(5)
    v_mfma_f32_32x32x16_bf16 v[16:31], v[204:207], v[44:47], v[16:31]
    ds_read_b64_tr_b16 v[40:41], v6 offset:22528
    ds_read_b64_tr_b16 v[42:43], v6 offset:22784
    s_waitcnt vmcnt(14)
    ds_read_b128 v[132:135], v7 offset:15360
    s_waitcnt lgkmcnt(6)
    v_mfma_f32_32x32x16_bf16 v[16:31], v[208:211], v[32:35], v[16:31]
    ds_read_b64_tr_b16 v[44:45], v6 offset:23552
    ds_read_b64_tr_b16 v[46:47], v6 offset:23808
    s_waitcnt vmcnt(13)
    ds_read_b128 v[136:139], v7 offset:16384
    s_waitcnt lgkmcnt(7)
    v_mfma_f32_32x32x16_bf16 v[16:31], v[212:215], v[36:39], v[16:31]
    ds_read_b64_tr_b16 v[32:33], v6 offset:24576
    ds_read_b64_tr_b16 v[34:35], v6 offset:24832
    s_waitcnt vmcnt(12)
    ds_read_b128 v[140:143], v7 offset:17408
    s_waitcnt lgkmcnt(7)
    v_mfma_f32_32x32x16_bf16 v[16:31], v[216:219], v[40:43], v[16:31]
    ds_read_b64_tr_b16 v[36:37], v6 offset:25600
    ds_read_b64_tr_b16 v[38:39], v6 offset:25856
    s_waitcnt vmcnt(11)
    ds_read_b128 v[144:147], v7 offset:18432
    s_waitcnt lgkmcnt(7)
    v_mfma_f32_32x32x16_bf16 v[16:31], v[220:223], v[44:47], v[16:31]
    ds_read_b64_tr_b16 v[40:41], v6 offset:26624
    ds_read_b64_tr_b16 v[42:43], v6 offset:26880
    s_waitcnt vmcnt(10)
    ds_read_b128 v[148:151], v7 offset:19456
    s_waitcnt lgkmcnt(7)
    v_mfma_f32_32x32x16_bf16 v[16:31], v[224:227], v[32:35], v[16:31]
    ds_read_b64_tr_b16 v[44:45], v6 offset:27648
    ds_read_b64_tr_b16 v[46:47], v6 offset:27904
    s_waitcnt vmcnt(9)
    ds_read_b128 v[152:155], v7 offset:20480
    s_waitcnt lgkmcnt(7)
    v_mfma_f32_32x32x16_bf16 v[16:31], v[228:231], v[36:39], v[16:31]
    ds_read_b64_tr_b16 v[32:33], v6 offset:28672
    ds_read_b64_tr_b16 v[34:35], v6 offset:28928
    s_waitcnt vmcnt(8)
    ds_read_b128 v[156:159], v7 offset:21504
    s_waitcnt lgkmcnt(7)
    v_mfma_f32_32x32x16_bf16 v[16:31], v[232:235], v[40:43], v[16:31]
    ds_read_b64_tr_b16 v[36:37], v6 offset:29696
    ds_read_b64_tr_b16 v[38:39], v6 offset:29952
    s_waitcnt vmcnt(5)
    ds_read_b128 v[160:163], v3 offset:22528
    s_waitcnt lgkmcnt(7)
    v_mfma_f32_32x32x16_bf16 v[16:31], v[236:239], v[44:47], v[16:31]
    ds_read_b64_tr_b16 v[40:41], v6 offset:30720
    ds_read_b64_tr_b16 v[42:43], v6 offset:30976
    s_waitcnt vmcnt(4)
    ds_read_b128 v[164:167], v3 offset:23552
    s_waitcnt lgkmcnt(7)
    v_mfma_f32_32x32x16_bf16 v[16:31], v[240:243], v[32:35], v[16:31]
    ds_read_b64_tr_b16 v[44:45], v6 offset:31744
    ds_read_b64_tr_b16 v[46:47], v6 offset:32000
    s_waitcnt vmcnt(3)
    ds_read_b128 v[168:171], v3 offset:24576
    s_waitcnt lgkmcnt(7)
    v_mfma_f32_32x32x16_bf16 v[16:31], v[244:247], v[36:39], v[16:31]
    s_waitcnt vmcnt(2)
    ds_read_b128 v[172:175], v3 offset:25600
    s_waitcnt lgkmcnt(5)
    v_mfma_f32_32x32x16_bf16 v[16:31], v[248:251], v[40:43], v[16:31]
    s_waitcnt vmcnt(1)
    ds_read_b128 v[176:179], v3 offset:26624
    s_waitcnt lgkmcnt(3)
    v_mfma_f32_32x32x16_bf16 v[16:31], v[252:255], v[44:47], v[16:31]
    s_waitcnt vmcnt(0)
    ds_read_b128 v[180:183], v3 offset:27648
    s_setprio 3
    s_mov_b32 s32, 0
    v_mov_b32 v5, 136368
sequential_preLN__ssm_conv_s4__dense_activation_squared_relu__prompt_kernel_sw10:
    ds_read_b32 v46, v5
    ds_read_b64 v[44:45], v10 offset:512
    ds_read_b32 v4, v10 offset:520
    s_add_u32 s32, s32, 1
    s_waitcnt lgkmcnt(0)
    v_cmp_gt_u32 vcc, 2, v46
    s_cmp_gt_u32 s32, 600000
    s_cbranch_scc1 sequential_preLN__ssm_conv_s4__dense_activation_squared_relu__prompt_kernel_sw10x
    s_cbranch_vccnz sequential_preLN__ssm_conv_s4__dense_activation_squared_relu__prompt_kernel_sw10
sequential_preLN__ssm_conv_s4__dense_activation_squared_relu__prompt_kernel_sw10x:
    v_mov_b32 v46, 0
    v_mov_b32 v47, 0
    s_nop 1
    v_mfma_f32_32x32x16_bf16 v[16:31], v[12:15], v[44:47], v[16:31]
    s_nop 15
    s_nop 7
    v_mul_f32 v16, v16, v4
    v_mul_f32 v17, v17, v4
    v_mul_f32 v18, v18, v4
    v_mul_f32 v19, v19, v4
    v_mul_f32 v20, v20, v4
    v_mul_f32 v21, v21, v4
    v_mul_f32 v22, v22, v4
    v_mul_f32 v23, v23, v4
    v_max_f32 v16, 0, v16
    v_max_f32 v17, 0, v17
    v_max_f32 v18, 0, v18
    v_max_f32 v19, 0, v19
    v_max_f32 v20, 0, v20
    v_max_f32 v21, 0, v21
    v_max_f32 v22, 0, v22
    v_max_f32 v23, 0, v23
    v_mul_f32 v16, v16, v16
    v_mul_f32 v17, v17, v17
    v_mul_f32 v18, v18, v18
    v_mul_f32 v19, v19, v19
    v_mul_f32 v20, v20, v20
    v_mul_f32 v21, v21, v21
    v_mul_f32 v22, v22, v22
    v_mul_f32 v23, v23, v23
    v_cvt_pk_bf16_f32 v56, v16, v17
    v_cvt_pk_bf16_f32 v57, v18, v19
    v_cvt_pk_bf16_f32 v58, v20, v21
    v_cvt_pk_bf16_f32 v59, v22, v23
    v_or_b32 v56, v56, v124
    v_or_b32 v57, v57, v125
    v_or_b32 v58, v58, v126
    v_or_b32 v59, v59, v127
    buffer_store_dwordx4 v[56:59], v2, s[36:39], s61 offen offset:0 sc1
    v_mul_f32 v24, v24, v4
    v_mul_f32 v25, v25, v4
    v_mul_f32 v26, v26, v4
    v_mul_f32 v27, v27, v4
    v_mul_f32 v28, v28, v4
    v_mul_f32 v29, v29, v4
    v_mul_f32 v30, v30, v4
    v_mul_f32 v31, v31, v4
    v_max_f32 v24, 0, v24
    v_max_f32 v25, 0, v25
    v_max_f32 v26, 0, v26
    v_max_f32 v27, 0, v27
    v_max_f32 v28, 0, v28
    v_max_f32 v29, 0, v29
    v_max_f32 v30, 0, v30
    v_max_f32 v31, 0, v31
    v_mul_f32 v24, v24, v24
    v_mul_f32 v25, v25, v25
    v_mul_f32 v26, v26, v26
    v_mul_f32 v27, v27, v27
    v_mul_f32 v28, v28, v28
    v_mul_f32 v29, v29, v29
    v_mul_f32 v30, v30, v30
    v_mul_f32 v31, v31, v31
    v_cvt_pk_bf16_f32 v60, v24, v25
    v_cvt_pk_bf16_f32 v61, v26, v27
    v_cvt_pk_bf16_f32 v62, v28, v29
    v_cvt_pk_bf16_f32 v63, v30, v31
    v_or_b32 v60, v60, v124
    v_or_b32 v61, v61, v125
    v_or_b32 v62, v62, v126
    v_or_b32 v63, v63, v127
    buffer_store_dwordx4 v[60:63], v2, s[36:39], s61 offen offset:1024 sc1
    s_setprio 0
    s_branch sequential_preLN__ssm_conv_s4__dense_activation_squared_relu__prompt_kernel_g24
sequential_preLN__ssm_conv_s4__dense_activation_squared_relu__prompt_kernel_mside2:
    s_mov_b32 s36, s98
    s_mov_b32 s37, s99
    s_mov_b32 s38, 0x2000000
    s_mov_b32 s39, 0x00020000
    v_lshrrev_b32 v108, 3, v1
    v_and_b32 v109, 7, v1
    v_lshlrev_b32 v109, 4, v109
    v_mov_b32 v104, -1
    v_mov_b32 v105, -1
    v_mov_b32 v106, -1
    v_mov_b32 v107, -1
    v_lshl_add_u32 v127, v108, 15, v109
    s_lshl_b32 s58, s25, 7
    s_lshl_b32 s32, s27, 18
    s_add_u32 s58, s58, s32
    s_add_u32 s58, s58, 0x500000
    s_add_u32 s59, s58, 0x100000
    s_mov_b32 s16, s40
    s_mov_b32 s17, s41
    s_mov_b32 s18, 0x1c0000
    s_mov_b32 s19, 0x00020000
    s_mov_b32 s20, s44
    s_mov_b32 s21, s45
    s_mov_b32 s22, 0x1c0000
    s_mov_b32 s23, 0x00020000
    s_cmp_lt_u32 s2, 224
    s_cselect_b32 s18, s18, 0
    s_cselect_b32 s22, s22, 0
    v_mul_u32_u24 v110, 3584, v108
    v_add_u32 v110, v110, v109
    v_lshl_add_u32 v122, v108, 10, v109
    s_lshl_b32 s31, s2, 2
    s_add_u32 s31, s31, s27
    s_and_b32 s33, s31, 31
    s_mul_i32 s34, s33, 57344
    s_lshl_b32 s35, s29, 7
    s_add_u32 s34, s34, s35
    s_add_u32 s35, s34, 28672
    s_add_u32 s32, s63, 2048
    s_mov_b32 m0, s32
    s_add_u32 s32, s63, 3072
    s_barrier
    s_mov_b32 s30, s34
    s_lshl_b32 s6, s29, 16
    s_lshl_b32 s33, s33, 10
    s_add_u32 s6, s6, s33
    s_add_u32 s6, s6, 0x100000
    s_mov_b32 s35, 38347923
    s_mul_hi_u32 s35, s31, s35
    s_mul_i32 s33, s35, 112
    s_sub_u32 s33, s31, s33
    s_lshl_b32 s33, s33, 14
    s_lshl_b32 s35, s35, 7
    s_add_u32 s34, s33, s35
    s_add_u32 s35, s34, 8192
    s_mov_b32 s26, s34
    v_mov_b32 v101, v122
    s_lshl_b32 s7, s31, 11
    s_add_u32 s7, s7, 0x300000
    s_cmp_lt_u32 s2, 224
    s_cselect_b32 s6, s6, 0x7fff0000
    s_cselect_b32 s7, s7, 0x7fff0000
    s_add_u32 s5, s6, 0x8000
    buffer_store_dwordx4 v[104:107], v127, s[36:39], s58 offen sc1
    buffer_store_dwordx4 v[104:107], v127, s[36:39], s59 offen sc1
    v_and_b32 v24, 3, v24
    v_lshrrev_b32 v29, 5, v1
    v_xor_b32 v26, v25, v29
    v_lshl_add_u32 v27, v25, 2, v24
    v_lshlrev_b32 v116, 6, v27
    v_lshl_add_u32 v116, v26, 4, v116
    v_and_b32 v30, 16, v1
    v_lshrrev_b32 v28, 1, v30
    v_add_u32 v116, v116, v28
    v_xor_b32 v117, 32, v116
    v_add_u32 v116, s63, v116
    v_add_u32 v117, s63, v117
    v_and_b32 v27, 4, v1
    v_lshlrev_b32 v27, 1, v27
    v_and_b32 v28, 1, v1
    v_lshl_add_u32 v27, v28, 2, v27
    v_bfe_u32 v28, v1, 3, 1
    v_lshl_add_u32 v27, v28, 1, v27
    v_bfe_u32 v28, v1, 1, 1
    v_add_u32 v27, v27, v28
    v_and_b32 v28, 48, v1
    v_add_u32 v118, v27, v28
    v_lshlrev_b32 v118, 2, v118
    v_lshl_add_u32 v119, v108, 14, v109
    s_and_b32 s32, s2, 3
    s_lshl_b32 s32, s32, 20
    s_lshl_b32 s33, s27, 18
    s_add_u32 s32, s32, s33
    s_lshr_b32 s33, s2, 2
    s_lshl_b32 s33, s33, 8
    s_add_u32 s60, s32, s33
    s_add_u32 s60, s60, 0x1000000
    s_add_u32 s61, s60, 0x20000
    v_lshlrev_b32 v28, 3, v25
    v_lshl_add_u32 v28, v30, 1, v28
    v_lshl_add_u32 v28, v24, 7, v28
    v_add_u32 v28, s63, v28
    v_lshl_add_u32 v120, v29, 10, v28
    v_lshl_add_u32 v121, v29, 9, v28
    global_load_dword v111, v102, s[96:97] sc1
    v_mov_b32 v96, v110
    buffer_load_dwordx4 v96, s[16:19], s30 offen lds
    s_add_u32 s32, s63, 3072
    s_mov_b32 m0, s32
    s_add_u32 s30, s30, 28672
    buffer_load_dwordx4 v96, s[16:19], s30 offen lds
    s_mov_b32 s100, s42
    s_mov_b32 s101, s43
    s_mov_b32 s48, s46
    s_mov_b32 s49, s47
    s_and_b32 s45, s29, 7
    s_lshr_b32 s52, s28, 1
    s_lshl_b32 s52, s52, 3
    s_add_u32 s52, s52, s45
    s_mov_b32 s45, 0
    s_and_b32 s53, s28, 1
    s_lshl_b32 s53, s53, 2
    s_lshr_b32 s33, s29, 3
    s_add_u32 s53, s53, s33
    s_lshl_b32 s52, s28, 2
    s_and_b32 s33, s29, 3
    s_add_u32 s52, s52, s33
    s_lshr_b32 s53, s29, 2
    s_lshr_b32 s33, s53, 1
    s_lshl_b32 s33, s33, 1
    s_add_u32 s3, s24, s33
    s_and_b32 s3, s3, 7
    s_mov_b32 s57, 0
    s_mul_i32 s54, s53, 7
    s_min_u32 s33, s24, 6
    s_add_u32 s54, s54, s33
    s_mov_b32 s40, s50
    s_mov_b32 s41, s51
    s_mov_b32 s42, 0x200000
    s_mov_b32 s43, 0x00020000
    s_lshl_b32 s33, s54, 15
    s_add_u32 s33, s33, 0x100000
    s_add_u32 s8, s98, s33
    s_addc_u32 s9, s99, 0
    s_cmp_eq_u32 s24, 7
    s_cselect_b32 s10, 0, 0x8000
    s_mov_b32 s11, 0x00020000
    s_lshl_b32 s56, s45, 12
    s_mul_i32 s33, s53, 229376
    s_mul_i32 s34, s3, 28672
    s_add_u32 s33, s33, s34
    s_add_u32 s33, s33, 0x300000
    s_add_u32 s12, s98, s33
    s_addc_u32 s13, s99, 0
    s_movk_i32 s14, 0x7000
    s_mov_b32 s15, 0x00020000
    s_mul_i32 s46, s24, 8224
    s_add_u32 s46, s46, 51712
    s_mul_i32 s44, s27, 6144
    s_add_u32 s44, s44, 114880
    v_and_b32 v123, 31, v1
    v_lshlrev_b32 v123, 2, v123
    v_lshl_add_u32 v123, v29, 10, v123
    v_add_u32 v123, 80896, v123
    v_and_b32 v122, 255, v0
    v_lshlrev_b32 v122, 2, v122
    v_add_u32 v122, 80896, v122
    s_lshl_b32 s4, s29, 11
    s_lshl_b32 s33, s28, 2
    s_add_u32 s4, s4, s33
    s_cmp_eq_u32 s24, 5
    s_cselect_b32 s4, s4, 0x7fff0000
    s_cmp_lt_u32 s2, 224
    s_cselect_b32 s4, s4, 0x7fff0000
    s_mov_b32 s62, 0x3f803f80
    v_mov_b32 v103, 0
    s_waitcnt vmcnt(7)
    ds_read_b64_tr_b16 v[52:53], v116
    ds_read_b64_tr_b16 v[54:55], v116 offset:1024
    ds_read_b64_tr_b16 v[56:57], v117
    ds_read_b64_tr_b16 v[58:59], v117 offset:1024
    s_waitcnt lgkmcnt(3)
    ds_bpermute_b32 v76, v118, v52
    ds_bpermute_b32 v77, v118, v53
    s_waitcnt lgkmcnt(4)
    ds_bpermute_b32 v80, v118, v54
    ds_bpermute_b32 v81, v118, v55
    s_waitcnt lgkmcnt(5)
    ds_bpermute_b32 v84, v118, v56
    ds_bpermute_b32 v85, v118, v57
    s_waitcnt lgkmcnt(6)
    ds_bpermute_b32 v88, v118, v58
    ds_bpermute_b32 v89, v118, v59
    s_waitcnt vmcnt(5)
    v_lshlrev_b32 v60, 16, v112
    v_and_b32 v61, s55, v112
    v_lshlrev_b32 v62, 16, v113
    v_and_b32 v63, s55, v113
    v_lshlrev_b32 v64, 16, v114
    v_and_b32 v65, s55, v114
    v_lshlrev_b32 v66, 16, v115
    v_and_b32 v67, s55, v115
    v_lshlrev_b32 v40, 16, v92
    v_and_b32 v41, s55, v92
    v_lshlrev_b32 v42, 16, v93
    v_and_b32 v43, s55, v93
    v_lshlrev_b32 v44, 16, v94
    v_and_b32 v45, s55, v94
    v_lshlrev_b32 v46, 16, v95
    v_and_b32 v47, s55, v95
    v_pk_add_f32 v[68:69], v[60:61], v[62:63]
    v_pk_mul_f32 v[70:71], v[60:61], v[60:61]
    v_pk_add_f32 v[48:49], v[40:41], v[42:43]
    v_pk_mul_f32 v[50:51], v[40:41], v[40:41]
    v_pk_fma_f32 v[70:71], v[62:63], v[62:63], v[70:71]
    v_pk_fma_f32 v[50:51], v[42:43], v[42:43], v[50:51]
    v_pk_fma_f32 v[70:71], v[64:65], v[64:65], v[70:71]
    v_pk_add_f32 v[68:69], v[68:69], v[64:65]
    v_pk_fma_f32 v[50:51], v[44:45], v[44:45], v[50:51]
    v_pk_add_f32 v[48:49], v[48:49], v[44:45]
    v_pk_fma_f32 v[70:71], v[66:67], v[66:67], v[70:71]
    v_pk_add_f32 v[68:69], v[68:69], v[66:67]
    v_pk_fma_f32 v[50:51], v[46:47], v[46:47], v[50:51]
    v_pk_add_f32 v[48:49], v[48:49], v[46:47]
    v_add_f32 v68, v68, v69
    v_add_f32 v70, v70, v71
    v_add_f32 v48, v48, v49
    v_add_f32 v50, v50, v51
    v_add_f32_dpp v68, v68, v68 quad_perm:[1,0,3,2] row_mask:0xf bank_mask:0xf
    v_add_f32_dpp v70, v70, v70 quad_perm:[1,0,3,2] row_mask:0xf bank_mask:0xf
    v_add_f32_dpp v48, v48, v48 quad_perm:[1,0,3,2] row_mask:0xf bank_mask:0xf
    v_add_f32_dpp v50, v50, v50 quad_perm:[1,0,3,2] row_mask:0xf bank_mask:0xf
    v_add_f32_dpp v68, v68, v68 quad_perm:[2,3,0,1] row_mask:0xf bank_mask:0xf
    v_add_f32_dpp v70, v70, v70 quad_perm:[2,3,0,1] row_mask:0xf bank_mask:0xf
    v_add_f32_dpp v48, v48, v48 quad_perm:[2,3,0,1] row_mask:0xf bank_mask:0xf
    v_add_f32_dpp v50, v50, v50 quad_perm:[2,3,0,1] row_mask:0xf bank_mask:0xf
    v_add_f32_dpp v68, v68, v68 row_half_mirror row_mask:0xf bank_mask:0xf
    v_add_f32_dpp v70, v70, v70 row_half_mirror row_mask:0xf bank_mask:0xf
    v_add_f32_dpp v48, v48, v48 row_half_mirror row_mask:0xf bank_mask:0xf
    v_add_f32_dpp v50, v50, v50 row_half_mirror row_mask:0xf bank_mask:0xf
    v_add_f32_dpp v68, v68, v68 row_mirror row_mask:0xf bank_mask:0xf
    v_add_f32_dpp v70, v70, v70 row_mirror row_mask:0xf bank_mask:0xf
    v_add_f32_dpp v48, v48, v48 row_mirror row_mask:0xf bank_mask:0xf
    v_add_f32_dpp v50, v50, v50 row_mirror row_mask:0xf bank_mask:0xf
    v_mov_b32 v69, v68
    v_mov_b32 v71, v70
    v_mov_b32 v49, v48
    v_mov_b32 v51, v50
    v_permlane16_swap_b32 v68, v69
    v_permlane16_swap_b32 v70, v71
    v_permlane16_swap_b32 v48, v49
    v_permlane16_swap_b32 v50, v51
    s_nop 0
    v_add_f32 v68, v68, v69
    v_add_f32 v70, v70, v71
    v_add_f32 v48, v48, v49
    v_add_f32 v50, v50, v51
    v_mov_b32 v69, v68
    v_mov_b32 v71, v70
    v_mov_b32 v49, v48
    v_mov_b32 v51, v50
    v_permlane32_swap_b32 v68, v69
    v_permlane32_swap_b32 v70, v71
    v_permlane32_swap_b32 v48, v49
    v_permlane32_swap_b32 v50, v51
    s_nop 0
    v_add_f32 v68, v68, v69
    v_add_f32 v70, v70, v71
    v_add_f32 v48, v48, v49
    v_add_f32 v50, v50, v51
    v_mul_f32 v68, 0x3b000000, v68
    v_mul_f32 v70, 0x3b000000, v70
    v_mul_f32 v48, 0x3b000000, v48
    v_mul_f32 v50, 0x3b000000, v50
    v_fma_f32 v70, -v68, v68, v70
    v_fma_f32 v50, -v48, v48, v50
    v_max_f32 v70, 0, v70
    v_max_f32 v50, 0, v50
    v_cvt_pk_bf16_f32 v72, v70, v50
    v_lshlrev_b32 v70, 16, v72
    v_and_b32 v50, s55, v72
    v_add_f32 v70, 0x3727c5ac, v70
    v_add_f32 v50, 0x3727c5ac, v50
    v_cvt_pk_bf16_f32 v72, v70, v50
    v_lshlrev_b32 v70, 16, v72
    v_and_b32 v50, s55, v72
    v_sqrt_f32 v70, v70
    v_sqrt_f32 v50, v50
    s_lshl_b32 s32, s27, 3
    s_add_u32 s32, s32, 136320
    v_mov_b32 v69, s32
    v_cvt_pk_bf16_f32 v72, v68, v70
    v_cvt_pk_bf16_f32 v73, v48, v50
    ds_write_b64 v69, v[72:73]
    v_lshlrev_b32 v26, 2, v1
    v_add_u32 v26, 136320, v26
    s_lshl_b32 s34, s2, 6
    s_add_u32 s34, s34, 65536
    v_lshlrev_b32 v27, 3, v1
    v_mov_b32 v98, 1
    s_mov_b32 s32, 0
    s_waitcnt vmcnt(2)
sequential_preLN__ssm_conv_s4__dense_activation_squared_relu__prompt_kernel_npoll11:
    v_readfirstlane_b32 s33, v111
    s_add_u32 s32, s32, 1
    s_cmp_lg_u32 s33, 0
    s_cbranch_scc1 sequential_preLN__ssm_conv_s4__dense_activation_squared_relu__prompt_kernel_gp12
    s_cmp_gt_u32 s32, 30000
    s_cbranch_scc1 sequential_preLN__ssm_conv_s4__dense_activation_squared_relu__prompt_kernel_gp12
    global_load_dword v111, v102, s[96:97] sc1
    s_waitcnt vmcnt(0)
    s_branch sequential_preLN__ssm_conv_s4__dense_activation_squared_relu__prompt_kernel_npoll11
sequential_preLN__ssm_conv_s4__dense_activation_squared_relu__prompt_kernel_gp12:
    s_mov_b64 exec, 1
    ds_add_rtn_u32 v97, v99, v98
    s_mov_b64 exec, 0xff
    ds_read_b32 v110, v26
    s_mov_b64 exec, -1
    v_not_b32 v100, v111
    v_mov_b32 v78, v111
    v_mov_b32 v79, v100
    v_mov_b32 v82, v111
    v_mov_b32 v83, v100
    v_mov_b32 v86, v111
    v_mov_b32 v87, v100
    v_mov_b32 v90, v111
    v_mov_b32 v91, v100
    s_waitcnt lgkmcnt(0)
    v_readfirstlane_b32 s33, v97
    s_mov_b64 exec, 0xff
    s_cmp_eq_u32 s33, 3
    s_cselect_b32 s34, s34, 0x7fff0000
    buffer_store_dwordx2 v[110:111], v27, s[36:39], s34 offen sc1
    s_mov_b64 exec, -1
    buffer_store_dwordx4 v[76:79], v119, s[36:39], s60 offen offset:0 sc1
    buffer_store_dwordx4 v[80:83], v119, s[36:39], s60 offen offset:128 sc1
    buffer_store_dwordx4 v[84:87], v119, s[36:39], s61 offen offset:0 sc1
    buffer_store_dwordx4 v[88:91], v119, s[36:39], s61 offen offset:128 sc1
    s_waitcnt vmcnt(5)
    ds_read_b64_tr_b16 v[40:41], v120 offset:2048
    ds_read_b64_tr_b16 v[42:43], v120 offset:2560
    ds_read_b64_tr_b16 v[44:45], v120 offset:2112
    ds_read_b64_tr_b16 v[46:47], v120 offset:2624
    s_add_u32 s32, s63, 4096
    s_mov_b32 m0, s32
    s_add_u32 s32, s63, 5120
    s_add_u32 s33, s26, 8192
    s_waitcnt lgkmcnt(2)
    buffer_store_dwordx4 v[40:43], v2, s[36:39], s6 offen sc1
    v_dot2_f32_bf16 v48, v40, s62, 0
    v_dot2_f32_bf16 v48, v41, s62, v48
    v_dot2_f32_bf16 v48, v42, s62, v48
    v_dot2_f32_bf16 v48, v43, s62, v48
    s_waitcnt lgkmcnt(0)
    buffer_store_dwordx4 v[44:47], v2, s[36:39], s5 offen sc1
    v_dot2_f32_bf16 v49, v44, s62, 0
    v_dot2_f32_bf16 v49, v45, s62, v49
    v_dot2_f32_bf16 v49, v46, s62, v49
    v_dot2_f32_bf16 v49, v47, s62, v49
    buffer_load_dwordx4 v101, s[20:23], s26 offen lds
    s_mov_b32 m0, s32
    s_nop 0
    buffer_load_dwordx4 v101, s[20:23], s33 offen lds
    ds_write_b32 v122, v48
    ds_write_b32 v122, v49 offset:1024
    v_mov_b32 v26, 136352
    ds_write_b32 v26, v111
    s_and_b32 s30, s27, 1
    v_lshrrev_b32 v25, 2, v1
    v_and_b32 v26, 1, v1
    v_lshl_add_u32 v25, v25, 1, v26
    v_bfe_u32 v27, v1, 1, 1
    s_lshl_b32 s35, s27, 10
    v_lshl_add_u32 v116, v25, 5, s63
    v_add_u32 v117, s63, v2
    v_lshl_add_u32 v25, v25, 3, s35
    v_mul_u32_u24 v119, 9280, v27
    v_add_u32 v119, v119, v25
    v_add_u32 v119, 109440, v119
    v_mul_u32_u24 v118, 4160, v27
    v_add_u32 v118, v118, v25
    v_add_u32 v118, 128000, v118
    v_and_b32 v26, 3, v1
    v_bfe_u32 v25, v1, 2, 1
    v_mul_u32_u24 v27, 320, v26
    v_lshl_add_u32 v27, v108, 5, v27
    v_mul_u32_u24 v28, 10256, v25
    v_add_u32 v27, v27, v28
    s_mul_i32 s35, s27, 1280
    s_add_u32 s35, s35, 66048
    v_add_u32 v124, s35, v27
    v_mul_u32_u24 v27, 4160, v25
    v_lshl_add_u32 v27, v108, 6, v27
    v_lshl_add_u32 v27, v26, 4, v27
    s_lshl_b32 s35, s27, 9
    s_add_u32 s35, s35, 128000
    v_add_u32 v125, s35, v27
    v_mul_u32_u24 v28, 4160, v108
    v_lshrrev_b32 v29, 1, v109
    v_add_u32 v28, v28, v29
    s_lshr_b32 s32, s27, 1
    s_mul_i32 s32, s32, 9280
    s_mul_i32 s35, s30, 4640
    s_add_u32 s32, s32, s35
    s_add_u32 s32, s32, 109440
    s_lshl_b32 s30, s30, 3
    v_lshlrev_b32 v26, 3, v1
    v_add_u32 v26, s32, v26
    v_add_u32 v27, s30, v26
    ds_write_b64 v26, v[102:103]
    ds_write_b64 v27, v[102:103]
    s_lshr_b32 s33, s54, 1
    s_lshl_b32 s33, s33, 10
    s_add_u32 s33, s33, 131072
    v_and_b32 v4, 7, v1
    v_lshl_add_u32 v4, v4, 7, s33
    s_lshl_b32 s33, s27, 12
    s_add_u32 s34, s33, 65536
    s_lshl_b32 s35, s25, 14
    s_add_u32 s35, s35, s33
    s_add_u32 s35, s35, 0x1000000
    v_mov_b32 v5, v111
    s_waitcnt vmcnt(2)
    s_mov_b64 exec, 1
    ds_add_rtn_u32 v97, v99, v98 offset:4
    s_lshl_b32 s32, s2, 7
    s_add_u32 s32, s32, 131072
    s_waitcnt lgkmcnt(0)
    v_readfirstlane_b32 s33, v97
    s_cmp_eq_u32 s33, 3
    s_cselect_b32 s32, s32, 0x7fff0000
    buffer_store_dword v111, v102, s[36:39], s32 offen sc1
    s_mov_b64 exec, -1
    s_waitcnt lgkmcnt(0)
    s_barrier
    s_setprio 3
    buffer_load_dwordx4 v[208:211], v2, s[36:39], s34 offen offset:0 sc1
    buffer_load_dwordx4 v[212:215], v2, s[36:39], s34 offen offset:1024 sc1
    buffer_load_dwordx4 v[216:219], v2, s[36:39], s34 offen offset:2048 sc1
    buffer_load_dwordx4 v[220:223], v2, s[36:39], s34 offen offset:3072 sc1
    buffer_load_dwordx4 v[224:227], v2, s[36:39], s35 offen offset:0 sc1
    buffer_load_dwordx4 v[228:231], v2, s[36:39], s35 offen offset:1024 sc1
    buffer_load_dwordx4 v[232:235], v2, s[36:39], s35 offen offset:2048 sc1
    buffer_load_dwordx4 v[236:239], v2, s[36:39], s35 offen offset:3072 sc1
    ds_write_b64 v28, v[102:103] offset:0
    s_waitcnt vmcnt(9)
    ds_read_b64_tr_b16 v[80:81], v121 offset:4096
    ds_read_b64_tr_b16 v[82:83], v121 offset:5120
    ds_read_b64_tr_b16 v[84:85], v121 offset:4160
    ds_read_b64_tr_b16 v[86:87], v121 offset:5184
    ds_read2_b32 v[88:89], v123 offset0:0 offset1:32
    ds_read2_b32 v[90:91], v123 offset0:64 offset1:96
    ds_read2_b32 v[92:93], v123 offset0:128 offset1:160
    ds_read2_b32 v[94:95], v123 offset0:192 offset1:224
    s_waitcnt lgkmcnt(0)
    v_pk_add_f32 v[88:89], v[88:89], v[90:91]
    v_pk_add_f32 v[92:93], v[92:93], v[94:95]
    v_pk_add_f32 v[88:89], v[88:89], v[92:93]
    v_add_f32 v88, v88, v89
    v_lshlrev_b32 v89, 5, v1
    s_mov_b32 s32, 0
    s_waitcnt vmcnt(0)
sequential_preLN__ssm_conv_s4__dense_activation_squared_relu__prompt_kernel_gl13:
    v_min3_u32 v24, v209, v211, v111
    v_max3_u32 v25, v209, v211, v111
    v_min3_u32 v24, v213, v215, v24
    v_max3_u32 v25, v213, v215, v25
    v_min3_u32 v24, v217, v219, v24
    v_max3_u32 v25, v217, v219, v25
    v_min3_u32 v24, v221, v223, v24
    v_max3_u32 v25, v221, v223, v25
    v_min3_u32 v24, v226, v230, v24
    v_max3_u32 v25, v226, v230, v25
    v_min3_u32 v24, v234, v238, v24
    v_max3_u32 v25, v234, v238, v25
    v_min3_u32 v26, v227, v231, v100
    v_max3_u32 v27, v227, v231, v100
    v_min3_u32 v26, v235, v239, v26
    v_max3_u32 v27, v235, v239, v27
    v_xor_b32 v24, v24, v25
    v_xor_b32 v26, v26, v27
    v_or_b32 v24, v24, v26
    v_cmp_ne_u32 vcc, 0, v24
    s_add_u32 s32, s32, 1
    s_cbranch_vccz sequential_preLN__ssm_conv_s4__dense_activation_squared_relu__prompt_kernel_gok14
    s_cmp_gt_u32 s32, 30000
    s_cbranch_scc1 sequential_preLN__ssm_conv_s4__dense_activation_squared_relu__prompt_kernel_gok14
    s_mov_b64 exec, vcc
    s_sleep 2
    buffer_load_dwordx4 v[208:211], v2, s[36:39], s34 offen offset:0 sc1
    buffer_load_dwordx4 v[212:215], v2, s[36:39], s34 offen offset:1024 sc1
    buffer_load_dwordx4 v[216:219], v2, s[36:39], s34 offen offset:2048 sc1
    buffer_load_dwordx4 v[220:223], v2, s[36:39], s34 offen offset:3072 sc1
    buffer_load_dwordx4 v[224:227], v2, s[36:39], s35 offen offset:0 sc1
    buffer_load_dwordx4 v[228:231], v2, s[36:39], s35 offen offset:1024 sc1
    buffer_load_dwordx4 v[232:235], v2, s[36:39], s35 offen offset:2048 sc1
    buffer_load_dwordx4 v[236:239], v2, s[36:39], s35 offen offset:3072 sc1
    s_waitcnt vmcnt(0)
    s_branch sequential_preLN__ssm_conv_s4__dense_activation_squared_relu__prompt_kernel_gl13
sequential_preLN__ssm_conv_s4__dense_activation_squared_relu__prompt_kernel_gok14:
    s_mov_b64 exec, -1
    buffer_load_dword v6, v4, s[36:39], 0 offen sc1
    buffer_store_dwordx4 v[80:83], v2, s[36:39], s7 offen sc1
    buffer_store_dwordx4 v[84:87], v2, s[36:39], s7 offen offset:1024 sc1
    buffer_store_dword v88, v89, s[36:39], s4 offen offset:0 sc1
    v_and_b32 v209, s55, v208
    v_and_b32 v211, s55, v210
    v_and_b32 v213, s55, v212
    v_and_b32 v215, s55, v214
    v_and_b32 v217, s55, v216
    v_and_b32 v219, s55, v218
    v_and_b32 v221, s55, v220
    v_and_b32 v223, s55, v222
    v_rcp_f32 v209, v209
    v_lshlrev_b32 v208, 16, v208
    v_rcp_f32 v211, v211
    v_lshlrev_b32 v210, 16, v210
    v_rcp_f32 v213, v213
    v_lshlrev_b32 v212, 16, v212
    v_rcp_f32 v215, v215
    v_lshlrev_b32 v214, 16, v214
    v_rcp_f32 v217, v217
    v_lshlrev_b32 v216, 16, v216
    v_rcp_f32 v219, v219
    v_lshlrev_b32 v218, 16, v218
    v_rcp_f32 v221, v221
    v_lshlrev_b32 v220, 16, v220
    v_rcp_f32 v223, v223
    v_lshlrev_b32 v222, 16, v222
    ds_write_b128 v117, v[208:211] offset:0
    ds_write_b128 v117, v[212:215] offset:1024
    ds_write_b128 v117, v[216:219] offset:2048
    ds_write_b128 v117, v[220:223] offset:3072
    ds_read_b128 v[30:33], v116 offset:0
    ds_read_b128 v[34:37], v116 offset:16
    ds_read_b128 v[38:41], v116 offset:1024
    ds_read_b128 v[42:45], v116 offset:1040
    ds_read_b128 v[46:49], v116 offset:2048
    ds_read_b128 v[50:53], v116 offset:2064
    ds_read_b128 v[54:57], v116 offset:3072
    ds_read_b128 v[58:61], v116 offset:3088
    v_lshlrev_b32 v64, 16, v224
    v_and_b32 v65, s55, v224
    v_lshlrev_b32 v66, 16, v225
    v_and_b32 v67, s55, v225
    v_lshlrev_b32 v68, 16, v228
    v_and_b32 v69, s55, v228
    v_lshlrev_b32 v70, 16, v229
    v_and_b32 v71, s55, v229
    v_lshlrev_b32 v72, 16, v232
    v_and_b32 v73, s55, v232
    v_lshlrev_b32 v74, 16, v233
    v_and_b32 v75, s55, v233
    v_lshlrev_b32 v76, 16, v236
    v_and_b32 v77, s55, v236
    v_lshlrev_b32 v78, 16, v237
    v_and_b32 v79, s55, v237
    s_waitcnt lgkmcnt(6)
    v_sub_f32 v64, v64, v30
    v_sub_f32 v65, v65, v32
    v_sub_f32 v66, v66, v34
    v_sub_f32 v67, v67, v36
    s_waitcnt lgkmcnt(4)
    v_sub_f32 v68, v68, v38
    v_sub_f32 v69, v69, v40
    v_sub_f32 v70, v70, v42
    v_sub_f32 v71, v71, v44
    s_waitcnt lgkmcnt(2)
    v_sub_f32 v72, v72, v46
    v_sub_f32 v73, v73, v48
    v_sub_f32 v74, v74, v50
    v_sub_f32 v75, v75, v52
    s_waitcnt lgkmcnt(0)
    v_sub_f32 v76, v76, v54
    v_sub_f32 v77, v77, v56
    v_sub_f32 v78, v78, v58
    v_sub_f32 v79, v79, v60
    ds_write_b64 v118, v[224:225] offset:0
    ds_write_b64 v118, v[228:229] offset:256
    ds_write_b64 v118, v[232:233] offset:512
    ds_write_b64 v118, v[236:237] offset:768
    v_cvt_pk_bf16_f32 v226, v64, v65
    v_cvt_pk_bf16_f32 v227, v66, v67
    v_cvt_pk_bf16_f32 v230, v68, v69
    v_cvt_pk_bf16_f32 v231, v70, v71
    v_cvt_pk_bf16_f32 v234, v72, v73
    v_cvt_pk_bf16_f32 v235, v74, v75
    v_cvt_pk_bf16_f32 v238, v76, v77
    v_cvt_pk_bf16_f32 v239, v78, v79
    v_lshlrev_b32 v64, 16, v226
    v_and_b32 v65, s55, v226
    v_lshlrev_b32 v66, 16, v227
    v_and_b32 v67, s55, v227
    v_lshlrev_b32 v68, 16, v230
    v_and_b32 v69, s55, v230
    v_lshlrev_b32 v70, 16, v231
    v_and_b32 v71, s55, v231
    v_lshlrev_b32 v72, 16, v234
    v_and_b32 v73, s55, v234
    v_lshlrev_b32 v74, 16, v235
    v_and_b32 v75, s55, v235
    v_lshlrev_b32 v76, 16, v238
    v_and_b32 v77, s55, v238
    v_lshlrev_b32 v78, 16, v239
    v_and_b32 v79, s55, v239
    v_mul_f32 v64, v64, v31
    v_mul_f32 v65, v65, v33
    v_mul_f32 v66, v66, v35
    v_mul_f32 v67, v67, v37
    v_cvt_pk_bf16_f32 v226, v64, v65
    v_cvt_pk_bf16_f32 v227, v66, v67
    ds_write_b64 v119, v[226:227] offset:512
    ds_write_b64 v119, v[226:227] offset:5160
    v_mul_f32 v68, v68, v39
    v_mul_f32 v69, v69, v41
    v_mul_f32 v70, v70, v43
    v_mul_f32 v71, v71, v45
    v_cvt_pk_bf16_f32 v230, v68, v69
    v_cvt_pk_bf16_f32 v231, v70, v71
    ds_write_b64 v119, v[230:231] offset:768
    ds_write_b64 v119, v[230:231] offset:5416
    v_mul_f32 v72, v72, v47
    v_mul_f32 v73, v73, v49
    v_mul_f32 v74, v74, v51
    v_mul_f32 v75, v75, v53
    v_cvt_pk_bf16_f32 v234, v72, v73
    v_cvt_pk_bf16_f32 v235, v74, v75
    ds_write_b64 v119, v[234:235] offset:1024
    ds_write_b64 v119, v[234:235] offset:5672
    v_mul_f32 v76, v76, v55
    v_mul_f32 v77, v77, v57
    v_mul_f32 v78, v78, v59
    v_mul_f32 v79, v79, v61
    v_cvt_pk_bf16_f32 v238, v76, v77
    v_cvt_pk_bf16_f32 v239, v78, v79
    ds_write_b64 v119, v[238:239] offset:1280
    ds_write_b64 v119, v[238:239] offset:5928
    s_mov_b32 s30, 0xfffffffe
    s_waitcnt lgkmcnt(0)
    s_setprio 0
    s_barrier
    ds_read_b128 v[16:19], v125
    ds_read_b128 v[20:23], v125 offset:2048
    s_mov_b32 s32, 0
    s_waitcnt vmcnt(3)
sequential_preLN__ssm_conv_s4__dense_activation_squared_relu__prompt_kernel_wl15:
    v_cmp_ne_u32 vcc, v5, v6
    s_add_u32 s32, s32, 1
    s_cbranch_vccz sequential_preLN__ssm_conv_s4__dense_activation_squared_relu__prompt_kernel_wok16
    s_cmp_gt_u32 s32, 30000
    s_cbranch_scc1 sequential_preLN__ssm_conv_s4__dense_activation_squared_relu__prompt_kernel_wok16
    s_sleep 4
    buffer_load_dword v6, v4, s[36:39], 0 offen sc1
    s_waitcnt vmcnt(0)
    s_branch sequential_preLN__ssm_conv_s4__dense_activation_squared_relu__prompt_kernel_wl15
sequential_preLN__ssm_conv_s4__dense_activation_squared_relu__prompt_kernel_wok16:
    buffer_load_dwordx4 v[128:131], v2, s[8:11], s56 offen offset:0 sc1
    buffer_load_dwordx4 v[132:135], v2, s[8:11], s56 offen offset:1024 sc1
    buffer_load_dwordx4 v[136:139], v2, s[8:11], s56 offen offset:2048 sc1
    buffer_load_dwordx4 v[140:143], v2, s[8:11], s56 offen offset:3072 sc1
    s_add_u32 s56, s56, 4096
    s_and_b32 s56, s56, 0x7fff
    buffer_load_dwordx4 v[144:147], v2, s[8:11], s56 offen offset:0 sc1
    buffer_load_dwordx4 v[148:151], v2, s[8:11], s56 offen offset:1024 sc1
    buffer_load_dwordx4 v[152:155], v2, s[8:11], s56 offen offset:2048 sc1
    buffer_load_dwordx4 v[156:159], v2, s[8:11], s56 offen offset:3072 sc1
    s_add_u32 s56, s56, 4096
    s_and_b32 s56, s56, 0x7fff
    s_lshl_b32 s6, s52, 15
    s_lshl_b32 s34, s27, 13
    s_add_u32 s6, s6, s34
    s_add_u32 s6, s6, 0x500000
    s_add_u32 s7, s6, 4096
    v_add_u32 v3, s34, v2
    s_waitcnt lgkmcnt(0)
    v_lshlrev_b32 v24, 16, v16
    v_and_b32 v25, s55, v16
    v_lshlrev_b32 v26, 16, v17
    v_and_b32 v27, s55, v17
    v_lshlrev_b32 v28, 16, v18
    v_and_b32 v29, s55, v18
    v_lshlrev_b32 v30, 16, v19
    v_and_b32 v31, s55, v19
    v_lshlrev_b32 v32, 16, v20
    v_and_b32 v33, s55, v20
    v_lshlrev_b32 v34, 16, v21
    v_and_b32 v35, s55, v21
    v_lshlrev_b32 v36, 16, v22
    v_and_b32 v37, s55, v22
    v_lshlrev_b32 v38, 16, v23
    v_and_b32 v39, s55, v23
    s_waitcnt vmcnt(8)
    s_setprio 3
    s_barrier
    ds_read_b128 v[40:43], v124 offset:16
    ds_read_b128 v[44:47], v124 offset:0
    ds_read_b128 v[48:51], v124 offset:5136
    ds_read_b128 v[52:55], v124 offset:5120
    s_waitcnt lgkmcnt(2)
    v_add_f32 v40, v40, v24
    v_add_f32 v41, v41, v25
    v_add_f32 v42, v42, v26
    v_add_f32 v43, v43, v27
    v_add_f32 v44, v44, v28
    v_add_f32 v45, v45, v29
    v_add_f32 v46, v46, v30
    v_add_f32 v47, v47, v31
    s_waitcnt lgkmcnt(0)
    v_add_f32 v40, v40, v48
    v_add_f32 v41, v41, v49
    v_add_f32 v42, v42, v50
    v_add_f32 v43, v43, v51
    v_add_f32 v44, v44, v52
    v_add_f32 v45, v45, v53
    v_add_f32 v46, v46, v54
    v_add_f32 v47, v47, v55
    v_cvt_pk_bf16_f32 v56, v40, v41
    v_cvt_pk_bf16_f32 v57, v42, v43
    v_cvt_pk_bf16_f32 v58, v44, v45
    v_cvt_pk_bf16_f32 v59, v46, v47
    v_min_u32 v56, s30, v56
    v_min_u32 v57, s30, v57
    v_min_u32 v58, s30, v58
    v_min_u32 v59, s30, v59
    buffer_store_dwordx4 v[56:59], v127, s[36:39], s58 offen sc1
    s_setprio 0
    buffer_load_dwordx4 v[160:163], v2, s[8:11], s56 offen offset:0 sc1
    buffer_load_dwordx4 v[164:167], v2, s[8:11], s56 offen offset:1024 sc1
    buffer_load_dwordx4 v[168:171], v2, s[8:11], s56 offen offset:2048 sc1
    buffer_load_dwordx4 v[172:175], v2, s[8:11], s56 offen offset:3072 sc1
    s_add_u32 s56, s56, 4096
    s_and_b32 s56, s56, 0x7fff
    buffer_load_dwordx4 v[176:179], v2, s[8:11], s56 offen offset:0 sc1
    buffer_load_dwordx4 v[180:183], v2, s[8:11], s56 offen offset:1024 sc1
    buffer_load_dwordx4 v[184:187], v2, s[8:11], s56 offen offset:2048 sc1
    buffer_load_dwordx4 v[188:191], v2, s[8:11], s56 offen offset:3072 sc1
    s_add_u32 s56, s56, 4096
    s_and_b32 s56, s56, 0x7fff
    buffer_load_dwordx4 v[192:195], v2, s[8:11], s56 offen offset:0 sc1
    buffer_load_dwordx4 v[196:199], v2, s[8:11], s56 offen offset:1024 sc1
    buffer_load_dwordx4 v[200:203], v2, s[8:11], s56 offen offset:2048 sc1
    buffer_load_dwordx4 v[204:207], v2, s[8:11], s56 offen offset:3072 sc1
    s_add_u32 s56, s56, 4096
    s_and_b32 s56, s56, 0x7fff
    buffer_load_dwordx4 v[208:211], v2, s[8:11], s56 offen offset:0 sc1
    buffer_load_dwordx4 v[212:215], v2, s[8:11], s56 offen offset:1024 sc1
    buffer_load_dwordx4 v[216:219], v2, s[8:11], s56 offen offset:2048 sc1
    buffer_load_dwordx4 v[220:223], v2, s[8:11], s56 offen offset:3072 sc1
    s_add_u32 s56, s56, 4096
    s_and_b32 s56, s56, 0x7fff
    v_readfirstlane_b32 s31, v5
    v_and_b32 v7, 15, v1
    v_lshrrev_b32 v8, 2, v7
    v_and_b32 v9, 3, v7
    v_lshlrev_b32 v9, 3, v9
    v_and_b32 v5, 31, v1
    v_lshlrev_b32 v10, 4, v5
    v_add_u32 v10, 136384, v10
    s_mul_i32 s61, s52, 56
    s_add_u32 s61, s61, s54
    s_lshl_b32 s61, s61, 11
    s_add_u32 s61, s61, 0x800000
    s_lshl_b32 s34, s53, 7
    v_lshl_add_u32 v15, v5, 2, s34
    s_lshl_b32 s34, s54, 6
    v_lshl_add_u32 v5, v5, 1, s34
    global_load_dword v11, v15, s[48:49]
    global_load_short_d16_hi v13, v5, s[100:101]
    v_lshrrev_b32 v4, 5, v1
    v_lshl_add_u32 v6, v4, 3, v8
    v_lshl_add_u32 v6, v6, 6, v9
    v_and_b32 v5, 16, v1
    v_lshl_add_u32 v6, v5, 1, v6
    v_and_b32 v5, 31, v1
    v_lshlrev_b32 v5, 5, v5
    v_lshl_add_u32 v14, v4, 4, v5
    s_lshl_b32 s60, s54, 10
    s_waitcnt vmcnt(18)
    buffer_load_dwordx4 v[64:67], v2, s[36:39], s6 offen offset:0 sc1
    buffer_load_dwordx4 v[68:71], v2, s[36:39], s6 offen offset:1024 sc1
    buffer_load_dwordx4 v[72:75], v2, s[36:39], s6 offen offset:2048 sc1
    buffer_load_dwordx4 v[76:79], v2, s[36:39], s6 offen offset:3072 sc1
    buffer_load_dwordx4 v[80:83], v2, s[36:39], s7 offen offset:0 sc1
    buffer_load_dwordx4 v[84:87], v2, s[36:39], s7 offen offset:1024 sc1
    buffer_load_dwordx4 v[88:91], v2, s[36:39], s7 offen offset:2048 sc1
    buffer_load_dwordx4 v[92:95], v2, s[36:39], s7 offen offset:3072 sc1
    s_setprio 3
    s_barrier
    ds_read_b128 v[40:43], v124 offset:20624
    ds_read_b128 v[44:47], v124 offset:20608
    ds_read_b128 v[48:51], v124 offset:25744
    ds_read_b128 v[52:55], v124 offset:25728
    s_waitcnt lgkmcnt(2)
    v_add_f32 v40, v40, v32
    v_add_f32 v41, v41, v33
    v_add_f32 v42, v42, v34
    v_add_f32 v43, v43, v35
    v_add_f32 v44, v44, v36
    v_add_f32 v45, v45, v37
    v_add_f32 v46, v46, v38
    v_add_f32 v47, v47, v39
    s_waitcnt lgkmcnt(0)
    v_add_f32 v40, v40, v48
    v_add_f32 v41, v41, v49
    v_add_f32 v42, v42, v50
    v_add_f32 v43, v43, v51
    v_add_f32 v44, v44, v52
    v_add_f32 v45, v45, v53
    v_add_f32 v46, v46, v54
    v_add_f32 v47, v47, v55
    v_cvt_pk_bf16_f32 v60, v40, v41
    v_cvt_pk_bf16_f32 v61, v42, v43
    v_cvt_pk_bf16_f32 v62, v44, v45
    v_cvt_pk_bf16_f32 v63, v46, v47
    v_min_u32 v60, s30, v60
    v_min_u32 v61, s30, v61
    v_min_u32 v62, s30, v62
    v_min_u32 v63, s30, v63
    buffer_store_dwordx4 v[60:63], v127, s[36:39], s59 offen sc1
    buffer_load_dwordx4 v[224:227], v2, s[8:11], s56 offen offset:0 sc1
    buffer_load_dwordx4 v[228:231], v2, s[8:11], s56 offen offset:1024 sc1
    buffer_load_dwordx4 v[232:235], v2, s[8:11], s56 offen offset:2048 sc1
    buffer_load_dwordx4 v[236:239], v2, s[8:11], s56 offen offset:3072 sc1
    s_add_u32 s56, s56, 4096
    s_and_b32 s56, s56, 0x7fff
    buffer_load_dwordx4 v[240:243], v2, s[8:11], s56 offen offset:0 sc1
    buffer_load_dwordx4 v[244:247], v2, s[8:11], s56 offen offset:1024 sc1
    buffer_load_dwordx4 v[248:251], v2, s[8:11], s56 offen offset:2048 sc1
    buffer_load_dwordx4 v[252:255], v2, s[8:11], s56 offen offset:3072 sc1
    s_mov_b32 s32, 0
    s_waitcnt vmcnt(9)
sequential_preLN__ssm_conv_s4__dense_activation_squared_relu__prompt_kernel_chkA17:
    v_max3_u32 v4, v64, v65, v66
    v_max_u32 v4, v4, v67
    v_max3_u32 v4, v68, v69, v4
    v_max3_u32 v4, v70, v71, v4
    v_max3_u32 v4, v72, v73, v4
    v_max3_u32 v4, v74, v75, v4
    v_max3_u32 v4, v76, v77, v4
    v_max3_u32 v4, v78, v79, v4
    v_max3_u32 v4, v80, v81, v4
    v_max3_u32 v4, v82, v83, v4
    v_max3_u32 v4, v84, v85, v4
    v_max3_u32 v4, v86, v87, v4
    v_max3_u32 v4, v88, v89, v4
    v_max3_u32 v4, v90, v91, v4
    v_max3_u32 v4, v92, v93, v4
    v_max3_u32 v4, v94, v95, v4
    v_cmp_eq_u32 vcc, -1, v4
    s_add_u32 s32, s32, 1
    s_cbranch_vccz sequential_preLN__ssm_conv_s4__dense_activation_squared_relu__prompt_kernel_okA18
    s_cmp_gt_u32 s32, 30000
    s_cbranch_scc1 sequential_preLN__ssm_conv_s4__dense_activation_squared_relu__prompt_kernel_okA18
    buffer_load_dwordx4 v[64:67], v2, s[36:39], s6 offen offset:0 sc1
    buffer_load_dwordx4 v[68:71], v2, s[36:39], s6 offen offset:1024 sc1
    buffer_load_dwordx4 v[72:75], v2, s[36:39], s6 offen offset:2048 sc1
    buffer_load_dwordx4 v[76:79], v2, s[36:39], s6 offen offset:3072 sc1
    buffer_load_dwordx4 v[80:83], v2, s[36:39], s7 offen offset:0 sc1
    buffer_load_dwordx4 v[84:87], v2, s[36:39], s7 offen offset:1024 sc1
    buffer_load_dwordx4 v[88:91], v2, s[36:39], s7 offen offset:2048 sc1
    buffer_load_dwordx4 v[92:95], v2, s[36:39], s7 offen offset:3072 sc1
    s_waitcnt vmcnt(0)
    s_branch sequential_preLN__ssm_conv_s4__dense_activation_squared_relu__prompt_kernel_chkA17
sequential_preLN__ssm_conv_s4__dense_activation_squared_relu__prompt_kernel_okA18:
    ds_write_b128 v3, v[64:67] offset:33280
    ds_write_b128 v3, v[68:71] offset:34304
    ds_write_b128 v3, v[72:75] offset:35328
    ds_write_b128 v3, v[76:79] offset:36352
    ds_write_b128 v3, v[80:83] offset:37376
    ds_write_b128 v3, v[84:87] offset:38400
    ds_write_b128 v3, v[88:91] offset:39424
    ds_write_b128 v3, v[92:95] offset:40448
    s_add_u32 s6, s6, 0x100000
    s_add_u32 s7, s7, 0x100000
    s_setprio 0
    s_cmp_eq_u32 s24, 7
    s_cbranch_scc1 sequential_preLN__ssm_conv_s4__dense_activation_squared_relu__prompt_kernel_stat19
    v_cmp_gt_u32 s[16:17], 32, v1
    v_add_u32 v7, s46, v2
    s_waitcnt lgkmcnt(0)
    s_barrier
    buffer_load_dwordx4 v[120:123], v14, s[36:39], s60 offen offset:0 sc1
    ds_read_b64_tr_b16 v[32:33], v6 offset:33280
    ds_read_b64_tr_b16 v[34:35], v6 offset:33536
    ds_read_b64_tr_b16 v[36:37], v6 offset:34304
    ds_read_b64_tr_b16 v[38:39], v6 offset:34560
    ds_read_b64_tr_b16 v[40:41], v6 offset:35328
    ds_read_b64_tr_b16 v[42:43], v6 offset:35584
    s_waitcnt lgkmcnt(4)
    v_mfma_f32_32x32x16_bf16 v[16:31], v[128:131], v[32:35], 0
    ds_read_b64_tr_b16 v[44:45], v6 offset:36352
    ds_read_b64_tr_b16 v[46:47], v6 offset:36608
    s_waitcnt lgkmcnt(4)
    v_mfma_f32_32x32x16_bf16 v[16:31], v[132:135], v[36:39], v[16:31]
    ds_read_b64_tr_b16 v[32:33], v6 offset:37376
    ds_read_b64_tr_b16 v[34:35], v6 offset:37632
    s_waitcnt lgkmcnt(4)
    v_mfma_f32_32x32x16_bf16 v[16:31], v[136:139], v[40:43], v[16:31]
    ds_read_b64_tr_b16 v[36:37], v6 offset:38400
    ds_read_b64_tr_b16 v[38:39], v6 offset:38656
    s_waitcnt lgkmcnt(4)
    v_mfma_f32_32x32x16_bf16 v[16:31], v[140:143], v[44:47], v[16:31]
    ds_read_b64_tr_b16 v[40:41], v6 offset:39424
    ds_read_b64_tr_b16 v[42:43], v6 offset:39680
    s_waitcnt lgkmcnt(4)
    v_mfma_f32_32x32x16_bf16 v[16:31], v[144:147], v[32:35], v[16:31]
    ds_read_b64_tr_b16 v[44:45], v6 offset:40448
    ds_read_b64_tr_b16 v[46:47], v6 offset:40704
    s_waitcnt lgkmcnt(4)
    v_mfma_f32_32x32x16_bf16 v[16:31], v[148:151], v[36:39], v[16:31]
    ds_read_b64_tr_b16 v[32:33], v6 offset:41472
    ds_read_b64_tr_b16 v[34:35], v6 offset:41728
    s_waitcnt lgkmcnt(4)
    v_mfma_f32_32x32x16_bf16 v[16:31], v[152:155], v[40:43], v[16:31]
    ds_read_b64_tr_b16 v[36:37], v6 offset:42496
    ds_read_b64_tr_b16 v[38:39], v6 offset:42752
    s_waitcnt lgkmcnt(4)
    v_mfma_f32_32x32x16_bf16 v[16:31], v[156:159], v[44:47], v[16:31]
    ds_read_b64_tr_b16 v[40:41], v6 offset:43520
    ds_read_b64_tr_b16 v[42:43], v6 offset:43776
    s_waitcnt lgkmcnt(4)
    v_mfma_f32_32x32x16_bf16 v[16:31], v[160:163], v[32:35], v[16:31]
    ds_read_b64_tr_b16 v[44:45], v6 offset:44544
    ds_read_b64_tr_b16 v[46:47], v6 offset:44800
    s_waitcnt lgkmcnt(4)
    v_mfma_f32_32x32x16_bf16 v[16:31], v[164:167], v[36:39], v[16:31]
    ds_read_b64_tr_b16 v[32:33], v6 offset:45568
    ds_read_b64_tr_b16 v[34:35], v6 offset:45824
    s_waitcnt lgkmcnt(4)
    v_mfma_f32_32x32x16_bf16 v[16:31], v[168:171], v[40:43], v[16:31]
    ds_read_b64_tr_b16 v[36:37], v6 offset:46592
    ds_read_b64_tr_b16 v[38:39], v6 offset:46848
    s_waitcnt lgkmcnt(4)
    v_mfma_f32_32x32x16_bf16 v[16:31], v[172:175], v[44:47], v[16:31]
    ds_read_b64_tr_b16 v[40:41], v6 offset:47616
    ds_read_b64_tr_b16 v[42:43], v6 offset:47872
    s_waitcnt lgkmcnt(4)
    v_mfma_f32_32x32x16_bf16 v[16:31], v[176:179], v[32:35], v[16:31]
    ds_read_b64_tr_b16 v[44:45], v6 offset:48640
    ds_read_b64_tr_b16 v[46:47], v6 offset:48896
    s_waitcnt lgkmcnt(4)
    v_mfma_f32_32x32x16_bf16 v[16:31], v[180:183], v[36:39], v[16:31]
    ds_read_b64_tr_b16 v[32:33], v6 offset:49664
    ds_read_b64_tr_b16 v[34:35], v6 offset:49920
    s_waitcnt lgkmcnt(4)
    v_mfma_f32_32x32x16_bf16 v[16:31], v[184:187], v[40:43], v[16:31]
    ds_read_b64_tr_b16 v[36:37], v6 offset:50688
    ds_read_b64_tr_b16 v[38:39], v6 offset:50944
    s_waitcnt lgkmcnt(4)
    v_mfma_f32_32x32x16_bf16 v[16:31], v[188:191], v[44:47], v[16:31]
    ds_read_b64_tr_b16 v[40:41], v6 offset:51712
    ds_read_b64_tr_b16 v[42:43], v6 offset:51968
    s_waitcnt lgkmcnt(4)
    v_mfma_f32_32x32x16_bf16 v[16:31], v[192:195], v[32:35], v[16:31]
    ds_read_b64_tr_b16 v[44:45], v6 offset:52736
    ds_read_b64_tr_b16 v[46:47], v6 offset:52992
    s_waitcnt lgkmcnt(4)
    v_mfma_f32_32x32x16_bf16 v[16:31], v[196:199], v[36:39], v[16:31]
    ds_read_b64_tr_b16 v[32:33], v6 offset:53760
    ds_read_b64_tr_b16 v[34:35], v6 offset:54016
    s_waitcnt lgkmcnt(4)
    v_mfma_f32_32x32x16_bf16 v[16:31], v[200:203], v[40:43], v[16:31]
    ds_read_b64_tr_b16 v[36:37], v6 offset:54784
    ds_read_b64_tr_b16 v[38:39], v6 offset:55040
    s_waitcnt lgkmcnt(4)
    v_mfma_f32_32x32x16_bf16 v[16:31], v[204:207], v[44:47], v[16:31]
    ds_read_b64_tr_b16 v[40:41], v6 offset:55808
    ds_read_b64_tr_b16 v[42:43], v6 offset:56064
    s_waitcnt lgkmcnt(4)
    v_mfma_f32_32x32x16_bf16 v[16:31], v[208:211], v[32:35], v[16:31]
    ds_read_b64_tr_b16 v[44:45], v6 offset:56832
    ds_read_b64_tr_b16 v[46:47], v6 offset:57088
    s_waitcnt lgkmcnt(4)
    v_mfma_f32_32x32x16_bf16 v[16:31], v[212:215], v[36:39], v[16:31]
    ds_read_b64_tr_b16 v[32:33], v6 offset:57856
    ds_read_b64_tr_b16 v[34:35], v6 offset:58112
    s_waitcnt lgkmcnt(4)
    v_mfma_f32_32x32x16_bf16 v[16:31], v[216:219], v[40:43], v[16:31]
    ds_read_b64_tr_b16 v[36:37], v6 offset:58880
    ds_read_b64_tr_b16 v[38:39], v6 offset:59136
    s_waitcnt lgkmcnt(4)
    v_mfma_f32_32x32x16_bf16 v[16:31], v[220:223], v[44:47], v[16:31]
    ds_read_b64_tr_b16 v[40:41], v6 offset:59904
    ds_read_b64_tr_b16 v[42:43], v6 offset:60160
    s_waitcnt vmcnt(5)
    s_waitcnt lgkmcnt(4)
    v_mfma_f32_32x32x16_bf16 v[16:31], v[224:227], v[32:35], v[16:31]
    ds_read_b64_tr_b16 v[44:45], v6 offset:60928
    ds_read_b64_tr_b16 v[46:47], v6 offset:61184
    s_waitcnt lgkmcnt(4)
    v_mfma_f32_32x32x16_bf16 v[16:31], v[228:231], v[36:39], v[16:31]
    ds_read_b64_tr_b16 v[32:33], v6 offset:61952
    ds_read_b64_tr_b16 v[34:35], v6 offset:62208
    s_waitcnt lgkmcnt(4)
    v_mfma_f32_32x32x16_bf16 v[16:31], v[232:235], v[40:43], v[16:31]
    ds_read_b64_tr_b16 v[36:37], v6 offset:62976
    ds_read_b64_tr_b16 v[38:39], v6 offset:63232
    s_waitcnt lgkmcnt(4)
    v_mfma_f32_32x32x16_bf16 v[16:31], v[236:239], v[44:47], v[16:31]
    ds_read_b64_tr_b16 v[40:41], v6 offset:64000
    ds_read_b64_tr_b16 v[42:43], v6 offset:64256
    s_waitcnt vmcnt(1)
    s_waitcnt lgkmcnt(4)
    v_mfma_f32_32x32x16_bf16 v[16:31], v[240:243], v[32:35], v[16:31]
    ds_read_b64_tr_b16 v[44:45], v6 offset:65024
    ds_read_b64_tr_b16 v[46:47], v6 offset:65280
    buffer_load_dwordx4 v[64:67], v2, s[36:39], s6 offen offset:0 sc1
    buffer_load_dwordx4 v[68:71], v2, s[36:39], s6 offen offset:1024 sc1
    buffer_load_dwordx4 v[72:75], v2, s[36:39], s6 offen offset:2048 sc1
    buffer_load_dwordx4 v[76:79], v2, s[36:39], s6 offen offset:3072 sc1
    buffer_load_dwordx4 v[80:83], v2, s[36:39], s7 offen offset:0 sc1
    buffer_load_dwordx4 v[84:87], v2, s[36:39], s7 offen offset:1024 sc1
    buffer_load_dwordx4 v[88:91], v2, s[36:39], s7 offen offset:2048 sc1
    buffer_load_dwordx4 v[92:95], v2, s[36:39], s7 offen offset:3072 sc1
    s_waitcnt lgkmcnt(4)
    v_mfma_f32_32x32x16_bf16 v[16:31], v[244:247], v[36:39], v[16:31]
    s_waitcnt lgkmcnt(2)
    v_mfma_f32_32x32x16_bf16 v[16:31], v[248:251], v[40:43], v[16:31]
    s_waitcnt lgkmcnt(0)
    v_mfma_f32_32x32x16_bf16 v[16:31], v[252:255], v[44:47], v[16:31]
    s_waitcnt vmcnt(8)
    v_add_f32 v122, v120, v122
    v_add_f32 v123, v121, v123
    v_add_f32 v123, v122, v123
    v_cvt_pk_bf16_f32 v14, v123, v123
    v_lshlrev_b32 v14, 16, v14
    v_sub_f32 v123, v123, v14
    v_cndmask_b32 v13, 0, v13, s[16:17]
    v_cvt_pk_bf16_f32 v15, v123, v123
    v_lshlrev_b32 v15, 16, v15
    v_sub_f32 v123, v123, v15
    v_cvt_pk_bf16_f32 v12, v14, v15
    v_mov_b32 v14, 0
    v_mov_b32 v15, 0
    v_cvt_pk_bf16_f32 v13, v123, v13
    v_and_b32 v4, 3, v1
    v_lshlrev_b32 v4, 3, v4
    v_lshrrev_b32 v4, v4, s31
    v_bfe_u32 v5, v4, 0, 1
    v_lshlrev_b32 v5, 15, v5
    v_lshrrev_b32 v124, 1, v4
    v_lshl_or_b32 v124, v124, 31, v5
    v_bfe_u32 v5, v4, 2, 1
    v_lshlrev_b32 v5, 15, v5
    v_lshrrev_b32 v125, 3, v4
    v_lshl_or_b32 v125, v125, 31, v5
    v_bfe_u32 v5, v4, 4, 1
    v_lshlrev_b32 v5, 15, v5
    v_lshrrev_b32 v126, 5, v4
    v_lshl_or_b32 v126, v126, 31, v5
    v_bfe_u32 v5, v4, 6, 1
    v_lshlrev_b32 v5, 15, v5
    v_lshrrev_b32 v127, 7, v4
    v_lshl_or_b32 v127, v127, 31, v5
    s_setprio 3
    s_mov_b32 s32, 0
    v_mov_b32 v5, 136368
sequential_preLN__ssm_conv_s4__dense_activation_squared_relu__prompt_kernel_sw20:
    ds_read_b32 v46, v5
    ds_read_b64 v[44:45], v10 offset:0
    ds_read_b32 v4, v10 offset:8
    s_add_u32 s32, s32, 1
    s_waitcnt lgkmcnt(0)
    v_cmp_gt_u32 vcc, 1, v46
    s_cmp_gt_u32 s32, 600000
    s_cbranch_scc1 sequential_preLN__ssm_conv_s4__dense_activation_squared_relu__prompt_kernel_sw20x
    s_cbranch_vccnz sequential_preLN__ssm_conv_s4__dense_activation_squared_relu__prompt_kernel_sw20
sequential_preLN__ssm_conv_s4__dense_activation_squared_relu__prompt_kernel_sw20x:
    v_mov_b32 v46, 0
    v_mov_b32 v47, 0
    s_nop 1
    v_mfma_f32_32x32x16_bf16 v[16:31], v[12:15], v[44:47], v[16:31]
    s_nop 15
    s_nop 7
    v_mul_f32 v16, v16, v4
    v_mul_f32 v17, v17, v4
    v_mul_f32 v18, v18, v4
    v_mul_f32 v19, v19, v4
    v_mul_f32 v20, v20, v4
    v_mul_f32 v21, v21, v4
    v_mul_f32 v22, v22, v4
    v_mul_f32 v23, v23, v4
    v_max_f32 v16, 0, v16
    v_max_f32 v17, 0, v17
    v_max_f32 v18, 0, v18
    v_max_f32 v19, 0, v19
    v_max_f32 v20, 0, v20
    v_max_f32 v21, 0, v21
    v_max_f32 v22, 0, v22
    v_max_f32 v23, 0, v23
    v_mul_f32 v16, v16, v16
    v_mul_f32 v17, v17, v17
    v_mul_f32 v18, v18, v18
    v_mul_f32 v19, v19, v19
    v_mul_f32 v20, v20, v20
    v_mul_f32 v21, v21, v21
    v_mul_f32 v22, v22, v22
    v_mul_f32 v23, v23, v23
    v_cvt_pk_bf16_f32 v48, v16, v17
    v_cvt_pk_bf16_f32 v49, v18, v19
    v_cvt_pk_bf16_f32 v50, v20, v21
    v_cvt_pk_bf16_f32 v51, v22, v23
    v_or_b32 v48, v48, v124
    v_or_b32 v49, v49, v125
    v_or_b32 v50, v50, v126
    v_or_b32 v51, v51, v127
    buffer_store_dwordx4 v[48:51], v2, s[36:39], s61 offen offset:0 sc1
    v_mul_f32 v24, v24, v4
    v_mul_f32 v25, v25, v4
    v_mul_f32 v26, v26, v4
    v_mul_f32 v27, v27, v4
    v_mul_f32 v28, v28, v4
    v_mul_f32 v29, v29, v4
    v_mul_f32 v30, v30, v4
    v_mul_f32 v31, v31, v4
    v_max_f32 v24, 0, v24
    v_max_f32 v25, 0, v25
    v_max_f32 v26, 0, v26
    v_max_f32 v27, 0, v27
    v_max_f32 v28, 0, v28
    v_max_f32 v29, 0, v29
    v_max_f32 v30, 0, v30
    v_max_f32 v31, 0, v31
    v_mul_f32 v24, v24, v24
    v_mul_f32 v25, v25, v25
    v_mul_f32 v26, v26, v26
    v_mul_f32 v27, v27, v27
    v_mul_f32 v28, v28, v28
    v_mul_f32 v29, v29, v29
    v_mul_f32 v30, v30, v30
    v_mul_f32 v31, v31, v31
    v_cvt_pk_bf16_f32 v52, v24, v25
    v_cvt_pk_bf16_f32 v53, v26, v27
    v_cvt_pk_bf16_f32 v54, v28, v29
    v_cvt_pk_bf16_f32 v55, v30, v31
    v_or_b32 v52, v52, v124
    v_or_b32 v53, v53, v125
    v_or_b32 v54, v54, v126
    v_or_b32 v55, v55, v127
    buffer_store_dwordx4 v[52:55], v2, s[36:39], s61 offen offset:1024 sc1
    s_setprio 0
    s_add_u32 s61, s61, 0x380000
    s_mov_b32 s32, 0
    s_waitcnt vmcnt(2)
sequential_preLN__ssm_conv_s4__dense_activation_squared_relu__prompt_kernel_chkA21:
    v_max3_u32 v4, v64, v65, v66
    v_max_u32 v4, v4, v67
    v_max3_u32 v4, v68, v69, v4
    v_max3_u32 v4, v70, v71, v4
    v_max3_u32 v4, v72, v73, v4
    v_max3_u32 v4, v74, v75, v4
    v_max3_u32 v4, v76, v77, v4
    v_max3_u32 v4, v78, v79, v4
    v_max3_u32 v4, v80, v81, v4
    v_max3_u32 v4, v82, v83, v4
    v_max3_u32 v4, v84, v85, v4
    v_max3_u32 v4, v86, v87, v4
    v_max3_u32 v4, v88, v89, v4
    v_max3_u32 v4, v90, v91, v4
    v_max3_u32 v4, v92, v93, v4
    v_max3_u32 v4, v94, v95, v4
    v_cmp_eq_u32 vcc, -1, v4
    s_add_u32 s32, s32, 1
    s_cbranch_vccz sequential_preLN__ssm_conv_s4__dense_activation_squared_relu__prompt_kernel_okA22
    s_cmp_gt_u32 s32, 30000
    s_cbranch_scc1 sequential_preLN__ssm_conv_s4__dense_activation_squared_relu__prompt_kernel_okA22
    buffer_load_dwordx4 v[64:67], v2, s[36:39], s6 offen offset:0 sc1
    buffer_load_dwordx4 v[68:71], v2, s[36:39], s6 offen offset:1024 sc1
    buffer_load_dwordx4 v[72:75], v2, s[36:39], s6 offen offset:2048 sc1
    buffer_load_dwordx4 v[76:79], v2, s[36:39], s6 offen offset:3072 sc1
    buffer_load_dwordx4 v[80:83], v2, s[36:39], s7 offen offset:0 sc1
    buffer_load_dwordx4 v[84:87], v2, s[36:39], s7 offen offset:1024 sc1
    buffer_load_dwordx4 v[88:91], v2, s[36:39], s7 offen offset:2048 sc1
    buffer_load_dwordx4 v[92:95], v2, s[36:39], s7 offen offset:3072 sc1
    s_waitcnt vmcnt(0)
    s_branch sequential_preLN__ssm_conv_s4__dense_activation_squared_relu__prompt_kernel_chkA21
sequential_preLN__ssm_conv_s4__dense_activation_squared_relu__prompt_kernel_okA22:
    ds_write_b128 v3, v[64:67] offset:0
    ds_write_b128 v3, v[68:71] offset:1024
    ds_write_b128 v3, v[72:75] offset:2048
    ds_write_b128 v3, v[76:79] offset:3072
    ds_write_b128 v3, v[80:83] offset:4096
    ds_write_b128 v3, v[84:87] offset:5120
    ds_write_b128 v3, v[88:91] offset:6144
    ds_write_b128 v3, v[92:95] offset:7168
    s_waitcnt lgkmcnt(0)
    buffer_load_dwordx4 v[64:67], v2, s[12:15], s57 offen offset:0 sc1
    buffer_load_dwordx4 v[68:71], v2, s[12:15], s57 offen offset:1024 sc1
    buffer_load_dwordx4 v[72:75], v2, s[12:15], s57 offen offset:2048 sc1
    buffer_load_dwordx4 v[76:79], v2, s[12:15], s57 offen offset:3072 sc1
    s_add_u32 s57, s57, 4096
    buffer_load_dwordx4 v[80:83], v2, s[12:15], s57 offen offset:0 sc1
    buffer_load_dwordx4 v[84:87], v2, s[12:15], s57 offen offset:1024 sc1
    buffer_load_dwordx4 v[88:91], v2, s[12:15], s57 offen offset:2048 sc1
    buffer_load_dwordx4 v[92:95], v2, s[12:15], s57 offen offset:3072 sc1
    s_add_u32 s57, s57, 4096
    buffer_load_dwordx4 v[96:99], v2, s[12:15], s57 offen offset:0 sc1
    buffer_load_dwordx4 v[100:103], v2, s[12:15], s57 offen offset:1024 sc1
    buffer_load_dwordx4 v[104:107], v2, s[12:15], s57 offen offset:2048 sc1
    buffer_load_dwordx4 v[108:111], v2, s[12:15], s57 offen offset:3072 sc1
    s_add_u32 s57, s57, 4096
    buffer_load_dwordx4 v[112:115], v2, s[12:15], s57 offen offset:0 sc1
    buffer_load_dwordx4 v[116:119], v2, s[12:15], s57 offen offset:1024 sc1
    s_add_u32 s47, s46, 12288
    s_mov_b32 m0, s47
    s_nop 0
    buffer_load_dwordx4 v2, s[12:15], s57 offen offset:2048 sc1 lds
    buffer_load_dwordx4 v2, s[12:15], s57 offen offset:3072 sc1 lds
    s_add_u32 s57, s57, 4096
    s_add_u32 s47, s46, 16384
    s_mov_b32 m0, s47
    s_nop 0
    buffer_load_dwordx4 v2, s[12:15], s57 offen offset:0 sc1 lds
    buffer_load_dwordx4 v2, s[12:15], s57 offen offset:1024 sc1 lds
    buffer_load_dwordx4 v2, s[12:15], s57 offen offset:2048 sc1 lds
    buffer_load_dwordx4 v2, s[12:15], s57 offen offset:3072 sc1 lds
    s_add_u32 s57, s57, 4096
    s_add_u32 s47, s46, 20480
    s_mov_b32 m0, s47
    s_nop 0
    buffer_load_dwordx4 v2, s[12:15], s57 offen offset:0 sc1 lds
    buffer_load_dwordx4 v2, s[12:15], s57 offen offset:1024 sc1 lds
    s_barrier
    ds_read_b64_tr_b16 v[32:33], v6 offset:0
    ds_read_b64_tr_b16 v[34:35], v6 offset:256
    ds_read_b64_tr_b16 v[36:37], v6 offset:1024
    ds_read_b64_tr_b16 v[38:39], v6 offset:1280
    ds_read_b64_tr_b16 v[40:41], v6 offset:2048
    ds_read_b64_tr_b16 v[42:43], v6 offset:2304
    s_waitcnt lgkmcnt(4)
    v_mfma_f32_32x32x16_bf16 v[16:31], v[128:131], v[32:35], 0
    ds_read_b64_tr_b16 v[44:45], v6 offset:3072
    ds_read_b64_tr_b16 v[46:47], v6 offset:3328
    s_waitcnt lgkmcnt(4)
    v_mfma_f32_32x32x16_bf16 v[16:31], v[132:135], v[36:39], v[16:31]
    ds_read_b64_tr_b16 v[32:33], v6 offset:4096
    ds_read_b64_tr_b16 v[34:35], v6 offset:4352
    s_waitcnt lgkmcnt(4)
    v_mfma_f32_32x32x16_bf16 v[16:31], v[136:139], v[40:43], v[16:31]
    ds_read_b64_tr_b16 v[36:37], v6 offset:5120
    ds_read_b64_tr_b16 v[38:39], v6 offset:5376
    s_waitcnt lgkmcnt(4)
    v_mfma_f32_32x32x16_bf16 v[16:31], v[140:143], v[44:47], v[16:31]
    ds_read_b64_tr_b16 v[40:41], v6 offset:6144
    ds_read_b64_tr_b16 v[42:43], v6 offset:6400
    s_waitcnt lgkmcnt(4)
    v_mfma_f32_32x32x16_bf16 v[16:31], v[144:147], v[32:35], v[16:31]
    ds_read_b64_tr_b16 v[44:45], v6 offset:7168
    ds_read_b64_tr_b16 v[46:47], v6 offset:7424
    s_waitcnt lgkmcnt(4)
    v_mfma_f32_32x32x16_bf16 v[16:31], v[148:151], v[36:39], v[16:31]
    ds_read_b64_tr_b16 v[32:33], v6 offset:8192
    ds_read_b64_tr_b16 v[34:35], v6 offset:8448
    s_waitcnt lgkmcnt(4)
    v_mfma_f32_32x32x16_bf16 v[16:31], v[152:155], v[40:43], v[16:31]
    ds_read_b64_tr_b16 v[36:37], v6 offset:9216
    ds_read_b64_tr_b16 v[38:39], v6 offset:9472
    s_waitcnt lgkmcnt(4)
    v_mfma_f32_32x32x16_bf16 v[16:31], v[156:159], v[44:47], v[16:31]
    ds_read_b64_tr_b16 v[40:41], v6 offset:10240
    ds_read_b64_tr_b16 v[42:43], v6 offset:10496
    s_waitcnt lgkmcnt(4)
    v_mfma_f32_32x32x16_bf16 v[16:31], v[160:163], v[32:35], v[16:31]
    ds_read_b64_tr_b16 v[44:45], v6 offset:11264
    ds_read_b64_tr_b16 v[46:47], v6 offset:11520
    s_waitcnt lgkmcnt(4)
    v_mfma_f32_32x32x16_bf16 v[16:31], v[164:167], v[36:39], v[16:31]
    ds_read_b64_tr_b16 v[32:33], v6 offset:12288
    ds_read_b64_tr_b16 v[34:35], v6 offset:12544
    s_waitcnt lgkmcnt(4)
    v_mfma_f32_32x32x16_bf16 v[16:31], v[168:171], v[40:43], v[16:31]
    ds_read_b64_tr_b16 v[36:37], v6 offset:13312
    ds_read_b64_tr_b16 v[38:39], v6 offset:13568
    buffer_load_dwordx4 v[160:163], v2, s[12:15], s57 offen offset:2048 sc1
    s_waitcnt lgkmcnt(4)
    v_mfma_f32_32x32x16_bf16 v[16:31], v[172:175], v[44:47], v[16:31]
    ds_read_b64_tr_b16 v[40:41], v6 offset:14336
    ds_read_b64_tr_b16 v[42:43], v6 offset:14592
    buffer_load_dwordx4 v[164:167], v2, s[12:15], s57 offen offset:3072 sc1
    s_add_u32 s57, s57, 4096
    s_waitcnt lgkmcnt(4)
    v_mfma_f32_32x32x16_bf16 v[16:31], v[176:179], v[32:35], v[16:31]
    ds_read_b64_tr_b16 v[44:45], v6 offset:15360
    ds_read_b64_tr_b16 v[46:47], v6 offset:15616
    buffer_load_dwordx4 v[168:171], v2, s[12:15], s57 offen offset:0 sc1
    s_waitcnt lgkmcnt(4)
    v_mfma_f32_32x32x16_bf16 v[16:31], v[180:183], v[36:39], v[16:31]
    ds_read_b64_tr_b16 v[32:33], v6 offset:16384
    ds_read_b64_tr_b16 v[34:35], v6 offset:16640
    buffer_load_dwordx4 v[172:175], v2, s[12:15], s57 offen offset:1024 sc1
    s_waitcnt lgkmcnt(4)
    v_mfma_f32_32x32x16_bf16 v[16:31], v[184:187], v[40:43], v[16:31]
    ds_read_b64_tr_b16 v[36:37], v6 offset:17408
    ds_read_b64_tr_b16 v[38:39], v6 offset:17664
    buffer_load_dwordx4 v[176:179], v2, s[12:15], s57 offen offset:2048 sc1
    s_waitcnt lgkmcnt(4)
    v_mfma_f32_32x32x16_bf16 v[16:31], v[188:191], v[44:47], v[16:31]
    ds_read_b64_tr_b16 v[40:41], v6 offset:18432
    ds_read_b64_tr_b16 v[42:43], v6 offset:18688
    buffer_load_dwordx4 v[180:183], v2, s[12:15], s57 offen offset:3072 sc1
    s_add_u32 s57, s57, 4096
    s_waitcnt lgkmcnt(4)
    v_mfma_f32_32x32x16_bf16 v[16:31], v[192:195], v[32:35], v[16:31]
    ds_read_b64_tr_b16 v[44:45], v6 offset:19456
    ds_read_b64_tr_b16 v[46:47], v6 offset:19712
    s_waitcnt lgkmcnt(4)
    v_mfma_f32_32x32x16_bf16 v[16:31], v[196:199], v[36:39], v[16:31]
    ds_read_b64_tr_b16 v[32:33], v6 offset:20480
    ds_read_b64_tr_b16 v[34:35], v6 offset:20736
    s_waitcnt lgkmcnt(4)
    v_mfma_f32_32x32x16_bf16 v[16:31], v[200:203], v[40:43], v[16:31]
    ds_read_b64_tr_b16 v[36:37], v6 offset:21504
    ds_read_b64_tr_b16 v[38:39], v6 offset:21760
    s_waitcnt lgkmcnt(4)
    v_mfma_f32_32x32x16_bf16 v[16:31], v[204:207], v[44:47], v[16:31]
    ds_read_b64_tr_b16 v[40:41], v6 offset:22528
    ds_read_b64_tr_b16 v[42:43], v6 offset:22784
    s_waitcnt lgkmcnt(4)
    v_mfma_f32_32x32x16_bf16 v[16:31], v[208:211], v[32:35], v[16:31]
    ds_read_b64_tr_b16 v[44:45], v6 offset:23552
    ds_read_b64_tr_b16 v[46:47], v6 offset:23808
    s_waitcnt lgkmcnt(4)
    v_mfma_f32_32x32x16_bf16 v[16:31], v[212:215], v[36:39], v[16:31]
    ds_read_b64_tr_b16 v[32:33], v6 offset:24576
    ds_read_b64_tr_b16 v[34:35], v6 offset:24832
    s_waitcnt lgkmcnt(4)
    v_mfma_f32_32x32x16_bf16 v[16:31], v[216:219], v[40:43], v[16:31]
    ds_read_b64_tr_b16 v[36:37], v6 offset:25600
    ds_read_b64_tr_b16 v[38:39], v6 offset:25856
    s_waitcnt lgkmcnt(4)
    v_mfma_f32_32x32x16_bf16 v[16:31], v[220:223], v[44:47], v[16:31]
    ds_read_b64_tr_b16 v[40:41], v6 offset:26624
    ds_read_b64_tr_b16 v[42:43], v6 offset:26880
    s_waitcnt lgkmcnt(4)
    v_mfma_f32_32x32x16_bf16 v[16:31], v[224:227], v[32:35], v[16:31]
    ds_read_b64_tr_b16 v[44:45], v6 offset:27648
    ds_read_b64_tr_b16 v[46:47], v6 offset:27904
    s_waitcnt lgkmcnt(4)
    v_mfma_f32_32x32x16_bf16 v[16:31], v[228:231], v[36:39], v[16:31]
    ds_read_b64_tr_b16 v[32:33], v6 offset:28672
    ds_read_b64_tr_b16 v[34:35], v6 offset:28928
    s_waitcnt lgkmcnt(4)
    v_mfma_f32_32x32x16_bf16 v[16:31], v[232:235], v[40:43], v[16:31]
    ds_read_b64_tr_b16 v[36:37], v6 offset:29696
    ds_read_b64_tr_b16 v[38:39], v6 offset:29952
    s_waitcnt lgkmcnt(4)
    v_mfma_f32_32x32x16_bf16 v[16:31], v[236:239], v[44:47], v[16:31]
    ds_read_b64_tr_b16 v[40:41], v6 offset:30720
    ds_read_b64_tr_b16 v[42:43], v6 offset:30976
    s_waitcnt lgkmcnt(4)
    v_mfma_f32_32x32x16_bf16 v[16:31], v[240:243], v[32:35], v[16:31]
    ds_read_b64_tr_b16 v[44:45], v6 offset:31744
    ds_read_b64_tr_b16 v[46:47], v6 offset:32000
    s_waitcnt lgkmcnt(4)
    v_mfma_f32_32x32x16_bf16 v[16:31], v[244:247], v[36:39], v[16:31]
    s_waitcnt lgkmcnt(2)
    v_mfma_f32_32x32x16_bf16 v[16:31], v[248:251], v[40:43], v[16:31]
    s_waitcnt lgkmcnt(0)
    v_mfma_f32_32x32x16_bf16 v[16:31], v[252:255], v[44:47], v[16:31]
    s_waitcnt vmcnt(13)
    ds_read_b128 v[128:131], v7 offset:14336
    s_waitcnt vmcnt(12)
    ds_read_b128 v[132:135], v7 offset:15360
    s_waitcnt vmcnt(11)
    ds_read_b128 v[136:139], v7 offset:16384
    s_waitcnt vmcnt(10)
    ds_read_b128 v[140:143], v7 offset:17408
    s_waitcnt vmcnt(9)
    ds_read_b128 v[144:147], v7 offset:18432
    s_waitcnt vmcnt(8)
    ds_read_b128 v[148:151], v7 offset:19456
    s_waitcnt vmcnt(7)
    ds_read_b128 v[152:155], v7 offset:20480
    s_waitcnt vmcnt(6)
    ds_read_b128 v[156:159], v7 offset:21504
    s_setprio 3
    s_mov_b32 s32, 0
    v_mov_b32 v5, 136368
sequential_preLN__ssm_conv_s4__dense_activation_squared_relu__prompt_kernel_sw23:
    ds_read_b32 v46, v5
    ds_read_b64 v[44:45], v10 offset:512
    ds_read_b32 v4, v10 offset:520
    s_add_u32 s32, s32, 1
    s_waitcnt lgkmcnt(0)
    v_cmp_gt_u32 vcc, 2, v46
    s_cmp_gt_u32 s32, 600000
    s_cbranch_scc1 sequential_preLN__ssm_conv_s4__dense_activation_squared_relu__prompt_kernel_sw23x
    s_cbranch_vccnz sequential_preLN__ssm_conv_s4__dense_activation_squared_relu__prompt_kernel_sw23
sequential_preLN__ssm_conv_s4__dense_activation_squared_relu__prompt_kernel_sw23x:
    v_mov_b32 v46, 0
    v_mov_b32 v47, 0
    s_nop 1
    v_mfma_f32_32x32x16_bf16 v[16:31], v[12:15], v[44:47], v[16:31]
    s_nop 15
    s_nop 7
    v_mul_f32 v16, v16, v4
    v_mul_f32 v17, v17, v4
    v_mul_f32 v18, v18, v4
    v_mul_f32 v19, v19, v4
    v_mul_f32 v20, v20, v4
    v_mul_f32 v21, v21, v4
    v_mul_f32 v22, v22, v4
    v_mul_f32 v23, v23, v4
    v_max_f32 v16, 0, v16
    v_max_f32 v17, 0, v17
    v_max_f32 v18, 0, v18
    v_max_f32 v19, 0, v19
    v_max_f32 v20, 0, v20
    v_max_f32 v21, 0, v21
    v_max_f32 v22, 0, v22
    v_max_f32 v23, 0, v23
    v_mul_f32 v16, v16, v16
    v_mul_f32 v17, v17, v17
    v_mul_f32 v18, v18, v18
    v_mul_f32 v19, v19, v19
    v_mul_f32 v20, v20, v20
    v_mul_f32 v21, v21, v21
    v_mul_f32 v22, v22, v22
    v_mul_f32 v23, v23, v23
    v_cvt_pk_bf16_f32 v56, v16, v17
    v_cvt_pk_bf16_f32 v57, v18, v19
    v_cvt_pk_bf16_f32 v58, v20, v21
    v_cvt_pk_bf16_f32 v59, v22, v23
    v_or_b32 v56, v56, v124
    v_or_b32 v57, v57, v125
    v_or_b32 v58, v58, v126
    v_or_b32 v59, v59, v127
    buffer_store_dwordx4 v[56:59], v2, s[36:39], s61 offen offset:0 sc1
    v_mul_f32 v24, v24, v4
    v_mul_f32 v25, v25, v4
    v_mul_f32 v26, v26, v4
    v_mul_f32 v27, v27, v4
    v_mul_f32 v28, v28, v4
    v_mul_f32 v29, v29, v4
    v_mul_f32 v30, v30, v4
    v_mul_f32 v31, v31, v4
    v_max_f32 v24, 0, v24
    v_max_f32 v25, 0, v25
    v_max_f32 v26, 0, v26
    v_max_f32 v27, 0, v27
    v_max_f32 v28, 0, v28
    v_max_f32 v29, 0, v29
    v_max_f32 v30, 0, v30
    v_max_f32 v31, 0, v31
    v_mul_f32 v24, v24, v24
    v_mul_f32 v25, v25, v25
    v_mul_f32 v26, v26, v26
    v_mul_f32 v27, v27, v27
    v_mul_f32 v28, v28, v28
    v_mul_f32 v29, v29, v29
    v_mul_f32 v30, v30, v30
    v_mul_f32 v31, v31, v31
    v_cvt_pk_bf16_f32 v60, v24, v25
    v_cvt_pk_bf16_f32 v61, v26, v27
    v_cvt_pk_bf16_f32 v62, v28, v29
    v_cvt_pk_bf16_f32 v63, v30, v31
    v_or_b32 v60, v60, v124
    v_or_b32 v61, v61, v125
    v_or_b32 v62, v62, v126
    v_or_b32 v63, v63, v127
    buffer_store_dwordx4 v[60:63], v2, s[36:39], s61 offen offset:1024 sc1
    s_setprio 0
    s_branch sequential_preLN__ssm_conv_s4__dense_activation_squared_relu__prompt_kernel_g24
sequential_preLN__ssm_conv_s4__dense_activation_squared_relu__prompt_kernel_stat19:
    v_lshrrev_b32 v5, 4, v1
    v_lshl_add_u32 v6, v5, 3, v8
    v_lshl_add_u32 v6, v6, 6, v9
    v_mov_b32 v12, 0x3f803f80
    v_mov_b32 v13, 0x3f803f80
    v_mov_b32 v14, 0x3f803f80
    v_mov_b32 v15, 0x3f803f80
    v_lshlrev_b32 v10, 4, v7
    v_add_u32 v10, 136384, v10
    v_cmp_eq_u32 s[62:63], v5, v8
    v_and_b32 v7, 3, v7
    v_cmp_eq_u32 s[16:17], 1, v7
    v_cmp_eq_u32 s[18:19], 2, v7
    v_cmp_eq_u32 s[20:21], 3, v7
    s_setprio 2
    s_waitcnt lgkmcnt(0)
    s_barrier
    ds_read_b64_tr_b16 v[32:33], v6 offset:33280
    ds_read_b64_tr_b16 v[34:35], v6 offset:33536
    ds_read_b64_tr_b16 v[36:37], v6 offset:33312
    ds_read_b64_tr_b16 v[38:39], v6 offset:33568
    ds_read_b64_tr_b16 v[40:41], v6 offset:35328
    ds_read_b64_tr_b16 v[42:43], v6 offset:35584
    s_waitcnt lgkmcnt(4)
    v_mfma_f32_16x16x32_bf16 v[16:19], v[32:35], v[32:35], 0
    v_mfma_f32_16x16x32_bf16 v[20:23], v[12:15], v[32:35], 0
    ds_read_b64_tr_b16 v[44:45], v6 offset:35360
    ds_read_b64_tr_b16 v[46:47], v6 offset:35616
    s_waitcnt lgkmcnt(4)
    v_mfma_f32_16x16x32_bf16 v[24:27], v[36:39], v[36:39], 0
    v_mfma_f32_16x16x32_bf16 v[28:31], v[12:15], v[36:39], 0
    ds_read_b64_tr_b16 v[32:33], v6 offset:37376
    ds_read_b64_tr_b16 v[34:35], v6 offset:37632
    s_waitcnt lgkmcnt(4)
    v_mfma_f32_16x16x32_bf16 v[16:19], v[40:43], v[40:43], v[16:19]
    v_mfma_f32_16x16x32_bf16 v[20:23], v[12:15], v[40:43], v[20:23]
    ds_read_b64_tr_b16 v[36:37], v6 offset:37408
    ds_read_b64_tr_b16 v[38:39], v6 offset:37664
    s_waitcnt lgkmcnt(4)
    v_mfma_f32_16x16x32_bf16 v[24:27], v[44:47], v[44:47], v[24:27]
    v_mfma_f32_16x16x32_bf16 v[28:31], v[12:15], v[44:47], v[28:31]
    ds_read_b64_tr_b16 v[40:41], v6 offset:39424
    ds_read_b64_tr_b16 v[42:43], v6 offset:39680
    s_waitcnt lgkmcnt(4)
    v_mfma_f32_16x16x32_bf16 v[16:19], v[32:35], v[32:35], v[16:19]
    v_mfma_f32_16x16x32_bf16 v[20:23], v[12:15], v[32:35], v[20:23]
    ds_read_b64_tr_b16 v[44:45], v6 offset:39456
    ds_read_b64_tr_b16 v[46:47], v6 offset:39712
    s_waitcnt lgkmcnt(4)
    v_mfma_f32_16x16x32_bf16 v[24:27], v[36:39], v[36:39], v[24:27]
    v_mfma_f32_16x16x32_bf16 v[28:31], v[12:15], v[36:39], v[28:31]
    ds_read_b64_tr_b16 v[32:33], v6 offset:41472
    ds_read_b64_tr_b16 v[34:35], v6 offset:41728
    s_waitcnt lgkmcnt(4)
    v_mfma_f32_16x16x32_bf16 v[16:19], v[40:43], v[40:43], v[16:19]
    v_mfma_f32_16x16x32_bf16 v[20:23], v[12:15], v[40:43], v[20:23]
    ds_read_b64_tr_b16 v[36:37], v6 offset:41504
    ds_read_b64_tr_b16 v[38:39], v6 offset:41760
    s_waitcnt lgkmcnt(4)
    v_mfma_f32_16x16x32_bf16 v[24:27], v[44:47], v[44:47], v[24:27]
    v_mfma_f32_16x16x32_bf16 v[28:31], v[12:15], v[44:47], v[28:31]
    ds_read_b64_tr_b16 v[40:41], v6 offset:43520
    ds_read_b64_tr_b16 v[42:43], v6 offset:43776
    s_waitcnt lgkmcnt(4)
    v_mfma_f32_16x16x32_bf16 v[16:19], v[32:35], v[32:35], v[16:19]
    v_mfma_f32_16x16x32_bf16 v[20:23], v[12:15], v[32:35], v[20:23]
    ds_read_b64_tr_b16 v[44:45], v6 offset:43552
    ds_read_b64_tr_b16 v[46:47], v6 offset:43808
    s_waitcnt lgkmcnt(4)
    v_mfma_f32_16x16x32_bf16 v[24:27], v[36:39], v[36:39], v[24:27]
    v_mfma_f32_16x16x32_bf16 v[28:31], v[12:15], v[36:39], v[28:31]
    ds_read_b64_tr_b16 v[32:33], v6 offset:45568
    ds_read_b64_tr_b16 v[34:35], v6 offset:45824
    s_waitcnt lgkmcnt(4)
    v_mfma_f32_16x16x32_bf16 v[16:19], v[40:43], v[40:43], v[16:19]
    v_mfma_f32_16x16x32_bf16 v[20:23], v[12:15], v[40:43], v[20:23]
    ds_read_b64_tr_b16 v[36:37], v6 offset:45600
    ds_read_b64_tr_b16 v[38:39], v6 offset:45856
    s_waitcnt lgkmcnt(4)
    v_mfma_f32_16x16x32_bf16 v[24:27], v[44:47], v[44:47], v[24:27]
    v_mfma_f32_16x16x32_bf16 v[28:31], v[12:15], v[44:47], v[28:31]
    ds_read_b64_tr_b16 v[40:41], v6 offset:47616
    ds_read_b64_tr_b16 v[42:43], v6 offset:47872
    s_waitcnt lgkmcnt(4)
    v_mfma_f32_16x16x32_bf16 v[16:19], v[32:35], v[32:35], v[16:19]
    v_mfma_f32_16x16x32_bf16 v[20:23], v[12:15], v[32:35], v[20:23]
    ds_read_b64_tr_b16 v[44:45], v6 offset:47648
    ds_read_b64_tr_b16 v[46:47], v6 offset:47904
    s_waitcnt lgkmcnt(4)
    v_mfma_f32_16x16x32_bf16 v[24:27], v[36:39], v[36:39], v[24:27]
    v_mfma_f32_16x16x32_bf16 v[28:31], v[12:15], v[36:39], v[28:31]
    ds_read_b64_tr_b16 v[32:33], v6 offset:49664
    ds_read_b64_tr_b16 v[34:35], v6 offset:49920
    s_waitcnt lgkmcnt(4)
    v_mfma_f32_16x16x32_bf16 v[16:19], v[40:43], v[40:43], v[16:19]
    v_mfma_f32_16x16x32_bf16 v[20:23], v[12:15], v[40:43], v[20:23]
    ds_read_b64_tr_b16 v[36:37], v6 offset:49696
    ds_read_b64_tr_b16 v[38:39], v6 offset:49952
    s_waitcnt lgkmcnt(4)
    v_mfma_f32_16x16x32_bf16 v[24:27], v[44:47], v[44:47], v[24:27]
    v_mfma_f32_16x16x32_bf16 v[28:31], v[12:15], v[44:47], v[28:31]
    ds_read_b64_tr_b16 v[40:41], v6 offset:51712
    ds_read_b64_tr_b16 v[42:43], v6 offset:51968
    s_waitcnt lgkmcnt(4)
    v_mfma_f32_16x16x32_bf16 v[16:19], v[32:35], v[32:35], v[16:19]
    v_mfma_f32_16x16x32_bf16 v[20:23], v[12:15], v[32:35], v[20:23]
    ds_read_b64_tr_b16 v[44:45], v6 offset:51744
    ds_read_b64_tr_b16 v[46:47], v6 offset:52000
    s_waitcnt lgkmcnt(4)
    v_mfma_f32_16x16x32_bf16 v[24:27], v[36:39], v[36:39], v[24:27]
    v_mfma_f32_16x16x32_bf16 v[28:31], v[12:15], v[36:39], v[28:31]
    ds_read_b64_tr_b16 v[32:33], v6 offset:53760
    ds_read_b64_tr_b16 v[34:35], v6 offset:54016
    s_waitcnt lgkmcnt(4)
    v_mfma_f32_16x16x32_bf16 v[16:19], v[40:43], v[40:43], v[16:19]
    v_mfma_f32_16x16x32_bf16 v[20:23], v[12:15], v[40:43], v[20:23]
    ds_read_b64_tr_b16 v[36:37], v6 offset:53792
    ds_read_b64_tr_b16 v[38:39], v6 offset:54048
    s_waitcnt lgkmcnt(4)
    v_mfma_f32_16x16x32_bf16 v[24:27], v[44:47], v[44:47], v[24:27]
    v_mfma_f32_16x16x32_bf16 v[28:31], v[12:15], v[44:47], v[28:31]
    ds_read_b64_tr_b16 v[40:41], v6 offset:55808
    ds_read_b64_tr_b16 v[42:43], v6 offset:56064
    s_waitcnt lgkmcnt(4)
    v_mfma_f32_16x16x32_bf16 v[16:19], v[32:35], v[32:35], v[16:19]
    v_mfma_f32_16x16x32_bf16 v[20:23], v[12:15], v[32:35], v[20:23]
    ds_read_b64_tr_b16 v[44:45], v6 offset:55840
    ds_read_b64_tr_b16 v[46:47], v6 offset:56096
    s_waitcnt lgkmcnt(4)
    v_mfma_f32_16x16x32_bf16 v[24:27], v[36:39], v[36:39], v[24:27]
    v_mfma_f32_16x16x32_bf16 v[28:31], v[12:15], v[36:39], v[28:31]
    ds_read_b64_tr_b16 v[32:33], v6 offset:57856
    ds_read_b64_tr_b16 v[34:35], v6 offset:58112
    s_waitcnt lgkmcnt(4)
    v_mfma_f32_16x16x32_bf16 v[16:19], v[40:43], v[40:43], v[16:19]
    v_mfma_f32_16x16x32_bf16 v[20:23], v[12:15], v[40:43], v[20:23]
    ds_read_b64_tr_b16 v[36:37], v6 offset:57888
    ds_read_b64_tr_b16 v[38:39], v6 offset:58144
    s_waitcnt lgkmcnt(4)
    v_mfma_f32_16x16x32_bf16 v[24:27], v[44:47], v[44:47], v[24:27]
    v_mfma_f32_16x16x32_bf16 v[28:31], v[12:15], v[44:47], v[28:31]
    ds_read_b64_tr_b16 v[40:41], v6 offset:59904
    ds_read_b64_tr_b16 v[42:43], v6 offset:60160
    s_waitcnt lgkmcnt(4)
    v_mfma_f32_16x16x32_bf16 v[16:19], v[32:35], v[32:35], v[16:19]
    v_mfma_f32_16x16x32_bf16 v[20:23], v[12:15], v[32:35], v[20:23]
    ds_read_b64_tr_b16 v[44:45], v6 offset:59936
    ds_read_b64_tr_b16 v[46:47], v6 offset:60192
    s_waitcnt lgkmcnt(4)
    v_mfma_f32_16x16x32_bf16 v[24:27], v[36:39], v[36:39], v[24:27]
    v_mfma_f32_16x16x32_bf16 v[28:31], v[12:15], v[36:39], v[28:31]
    ds_read_b64_tr_b16 v[32:33], v6 offset:61952
    ds_read_b64_tr_b16 v[34:35], v6 offset:62208
    s_waitcnt lgkmcnt(4)
    v_mfma_f32_16x16x32_bf16 v[16:19], v[40:43], v[40:43], v[16:19]
    v_mfma_f32_16x16x32_bf16 v[20:23], v[12:15], v[40:43], v[20:23]
    ds_read_b64_tr_b16 v[36:37], v6 offset:61984
    ds_read_b64_tr_b16 v[38:39], v6 offset:62240
    s_waitcnt lgkmcnt(4)
    v_mfma_f32_16x16x32_bf16 v[24:27], v[44:47], v[44:47], v[24:27]
    v_mfma_f32_16x16x32_bf16 v[28:31], v[12:15], v[44:47], v[28:31]
    ds_read_b64_tr_b16 v[40:41], v6 offset:64000
    ds_read_b64_tr_b16 v[42:43], v6 offset:64256
    s_waitcnt lgkmcnt(4)
    v_mfma_f32_16x16x32_bf16 v[16:19], v[32:35], v[32:35], v[16:19]
    v_mfma_f32_16x16x32_bf16 v[20:23], v[12:15], v[32:35], v[20:23]
    ds_read_b64_tr_b16 v[44:45], v6 offset:64032
    ds_read_b64_tr_b16 v[46:47], v6 offset:64288
    buffer_load_dwordx4 v[64:67], v2, s[36:39], s6 offen offset:0 sc1
    buffer_load_dwordx4 v[68:71], v2, s[36:39], s6 offen offset:1024 sc1
    buffer_load_dwordx4 v[72:75], v2, s[36:39], s6 offen offset:2048 sc1
    buffer_load_dwordx4 v[76:79], v2, s[36:39], s6 offen offset:3072 sc1
    buffer_load_dwordx4 v[80:83], v2, s[36:39], s7 offen offset:0 sc1
    buffer_load_dwordx4 v[84:87], v2, s[36:39], s7 offen offset:1024 sc1
    buffer_load_dwordx4 v[88:91], v2, s[36:39], s7 offen offset:2048 sc1
    buffer_load_dwordx4 v[92:95], v2, s[36:39], s7 offen offset:3072 sc1
    s_waitcnt lgkmcnt(4)
    v_mfma_f32_16x16x32_bf16 v[24:27], v[36:39], v[36:39], v[24:27]
    v_mfma_f32_16x16x32_bf16 v[28:31], v[12:15], v[36:39], v[28:31]
    s_waitcnt lgkmcnt(2)
    v_mfma_f32_16x16x32_bf16 v[16:19], v[40:43], v[40:43], v[16:19]
    v_mfma_f32_16x16x32_bf16 v[20:23], v[12:15], v[40:43], v[20:23]
    s_waitcnt lgkmcnt(0)
    v_mfma_f32_16x16x32_bf16 v[24:27], v[44:47], v[44:47], v[24:27]
    v_mfma_f32_16x16x32_bf16 v[28:31], v[12:15], v[44:47], v[28:31]
    s_nop 15
    v_cndmask_b32 v16, v16, v17, s[16:17]
    v_cndmask_b32 v16, v16, v18, s[18:19]
    v_cndmask_b32 v16, v16, v19, s[20:21]
    v_cndmask_b32 v24, v24, v25, s[16:17]
    v_cndmask_b32 v24, v24, v26, s[18:19]
    v_cndmask_b32 v24, v24, v27, s[20:21]
    v_mul_f32 v20, 0x3b000000, v20
    v_mul_f32 v16, 0x3b000000, v16
    v_mul_f32 v28, 0x3b000000, v28
    v_mul_f32 v24, 0x3b000000, v24
    v_fma_f32 v16, -v20, v20, v16
    v_max_f32 v16, 0, v16
    v_fma_f32 v24, -v28, v28, v24
    v_max_f32 v24, 0, v24
    v_cvt_pk_bf16_f32 v16, v16, v16
    v_lshlrev_b32 v16, 16, v16
    v_cvt_pk_bf16_f32 v24, v24, v24
    v_lshlrev_b32 v24, 16, v24
    v_add_f32 v16, 0x3727c5ac, v16
    v_add_f32 v24, 0x3727c5ac, v24
    v_cvt_pk_bf16_f32 v16, v16, v16
    v_lshlrev_b32 v16, 16, v16
    v_cvt_pk_bf16_f32 v24, v24, v24
    v_lshlrev_b32 v24, 16, v24
    v_sqrt_f32 v16, v16
    v_sqrt_f32 v24, v24
    s_nop 0
    v_cvt_pk_bf16_f32 v16, v16, v16
    v_lshlrev_b32 v16, 16, v16
    v_cvt_pk_bf16_f32 v24, v24, v24
    v_lshlrev_b32 v24, 16, v24
    v_rcp_f32 v22, v16
    v_cvt_pk_bf16_f32 v21, -v20, v16
    v_cvt_pk_bf16_f32 v20, -v20, -v20
    v_rcp_f32 v30, v24
    v_cvt_pk_bf16_f32 v29, -v28, v24
    v_cvt_pk_bf16_f32 v28, -v28, -v28
    s_mov_b64 exec, s[62:63]
    ds_write_b128 v10, v[20:23] offset:0
    ds_write_b128 v10, v[28:31] offset:256
    s_mov_b64 exec, -1
    v_mov_b32 v4, 136368
    v_mov_b32 v5, 1
    ds_write_b32 v4, v5
    s_setprio 0
    s_mov_b32 s32, 0
    s_waitcnt vmcnt(0)
sequential_preLN__ssm_conv_s4__dense_activation_squared_relu__prompt_kernel_chkA24:
    v_max3_u32 v4, v64, v65, v66
    v_max_u32 v4, v4, v67
    v_max3_u32 v4, v68, v69, v4
    v_max3_u32 v4, v70, v71, v4
    v_max3_u32 v4, v72, v73, v4
    v_max3_u32 v4, v74, v75, v4
    v_max3_u32 v4, v76, v77, v4
    v_max3_u32 v4, v78, v79, v4
    v_max3_u32 v4, v80, v81, v4
    v_max3_u32 v4, v82, v83, v4
    v_max3_u32 v4, v84, v85, v4
    v_max3_u32 v4, v86, v87, v4
    v_max3_u32 v4, v88, v89, v4
    v_max3_u32 v4, v90, v91, v4
    v_max3_u32 v4, v92, v93, v4
    v_max3_u32 v4, v94, v95, v4
    v_cmp_eq_u32 vcc, -1, v4
    s_add_u32 s32, s32, 1
    s_cbranch_vccz sequential_preLN__ssm_conv_s4__dense_activation_squared_relu__prompt_kernel_okA25
    s_cmp_gt_u32 s32, 30000
    s_cbranch_scc1 sequential_preLN__ssm_conv_s4__dense_activation_squared_relu__prompt_kernel_okA25
    buffer_load_dwordx4 v[64:67], v2, s[36:39], s6 offen offset:0 sc1
    buffer_load_dwordx4 v[68:71], v2, s[36:39], s6 offen offset:1024 sc1
    buffer_load_dwordx4 v[72:75], v2, s[36:39], s6 offen offset:2048 sc1
    buffer_load_dwordx4 v[76:79], v2, s[36:39], s6 offen offset:3072 sc1
    buffer_load_dwordx4 v[80:83], v2, s[36:39], s7 offen offset:0 sc1
    buffer_load_dwordx4 v[84:87], v2, s[36:39], s7 offen offset:1024 sc1
    buffer_load_dwordx4 v[88:91], v2, s[36:39], s7 offen offset:2048 sc1
    buffer_load_dwordx4 v[92:95], v2, s[36:39], s7 offen offset:3072 sc1
    s_waitcnt vmcnt(0)
    s_branch sequential_preLN__ssm_conv_s4__dense_activation_squared_relu__prompt_kernel_chkA24
sequential_preLN__ssm_conv_s4__dense_activation_squared_relu__prompt_kernel_okA25:
    ds_write_b128 v3, v[64:67] offset:0
    ds_write_b128 v3, v[68:71] offset:1024
    ds_write_b128 v3, v[72:75] offset:2048
    ds_write_b128 v3, v[76:79] offset:3072
    ds_write_b128 v3, v[80:83] offset:4096
    ds_write_b128 v3, v[84:87] offset:5120
    ds_write_b128 v3, v[88:91] offset:6144
    ds_write_b128 v3, v[92:95] offset:7168
    s_waitcnt lgkmcnt(0)
    buffer_load_dwordx4 v[64:67], v2, s[12:15], s57 offen offset:0 sc1
    buffer_load_dwordx4 v[68:71], v2, s[12:15], s57 offen offset:1024 sc1
    buffer_load_dwordx4 v[72:75], v2, s[12:15], s57 offen offset:2048 sc1
    buffer_load_dwordx4 v[76:79], v2, s[12:15], s57 offen offset:3072 sc1
    s_add_u32 s57, s57, 4096
    buffer_load_dwordx4 v[80:83], v2, s[12:15], s57 offen offset:0 sc1
    buffer_load_dwordx4 v[84:87], v2, s[12:15], s57 offen offset:1024 sc1
    buffer_load_dwordx4 v[88:91], v2, s[12:15], s57 offen offset:2048 sc1
    buffer_load_dwordx4 v[92:95], v2, s[12:15], s57 offen offset:3072 sc1
    s_add_u32 s57, s57, 4096
    buffer_load_dwordx4 v[96:99], v2, s[12:15], s57 offen offset:0 sc1
    buffer_load_dwordx4 v[100:103], v2, s[12:15], s57 offen offset:1024 sc1
    buffer_load_dwordx4 v[104:107], v2, s[12:15], s57 offen offset:2048 sc1
    buffer_load_dwordx4 v[108:111], v2, s[12:15], s57 offen offset:3072 sc1
    s_add_u32 s57, s57, 4096
    buffer_load_dwordx4 v[112:115], v2, s[12:15], s57 offen offset:0 sc1
    buffer_load_dwordx4 v[116:119], v2, s[12:15], s57 offen offset:1024 sc1
    buffer_load_dwordx4 v[128:131], v2, s[12:15], s57 offen offset:2048 sc1
    buffer_load_dwordx4 v[132:135], v2, s[12:15], s57 offen offset:3072 sc1
    s_add_u32 s57, s57, 4096
    buffer_load_dwordx4 v[136:139], v2, s[12:15], s57 offen offset:0 sc1
    buffer_load_dwordx4 v[140:143], v2, s[12:15], s57 offen offset:1024 sc1
    buffer_load_dwordx4 v[144:147], v2, s[12:15], s57 offen offset:2048 sc1
    buffer_load_dwordx4 v[148:151], v2, s[12:15], s57 offen offset:3072 sc1
    s_add_u32 s57, s57, 4096
    buffer_load_dwordx4 v[152:155], v2, s[12:15], s57 offen offset:0 sc1
    buffer_load_dwordx4 v[156:159], v2, s[12:15], s57 offen offset:1024 sc1
    s_setprio 2
    s_barrier
    ds_read_b64_tr_b16 v[32:33], v6 offset:0
    ds_read_b64_tr_b16 v[34:35], v6 offset:256
    ds_read_b64_tr_b16 v[36:37], v6 offset:32
    ds_read_b64_tr_b16 v[38:39], v6 offset:288
    ds_read_b64_tr_b16 v[40:41], v6 offset:2048
    ds_read_b64_tr_b16 v[42:43], v6 offset:2304
    s_waitcnt lgkmcnt(4)
    v_mfma_f32_16x16x32_bf16 v[16:19], v[32:35], v[32:35], 0
    v_mfma_f32_16x16x32_bf16 v[20:23], v[12:15], v[32:35], 0
    ds_read_b64_tr_b16 v[44:45], v6 offset:2080
    ds_read_b64_tr_b16 v[46:47], v6 offset:2336
    s_waitcnt lgkmcnt(4)
    v_mfma_f32_16x16x32_bf16 v[24:27], v[36:39], v[36:39], 0
    v_mfma_f32_16x16x32_bf16 v[28:31], v[12:15], v[36:39], 0
    ds_read_b64_tr_b16 v[32:33], v6 offset:4096
    ds_read_b64_tr_b16 v[34:35], v6 offset:4352
    s_waitcnt lgkmcnt(4)
    v_mfma_f32_16x16x32_bf16 v[16:19], v[40:43], v[40:43], v[16:19]
    v_mfma_f32_16x16x32_bf16 v[20:23], v[12:15], v[40:43], v[20:23]
    ds_read_b64_tr_b16 v[36:37], v6 offset:4128
    ds_read_b64_tr_b16 v[38:39], v6 offset:4384
    s_waitcnt lgkmcnt(4)
    v_mfma_f32_16x16x32_bf16 v[24:27], v[44:47], v[44:47], v[24:27]
    v_mfma_f32_16x16x32_bf16 v[28:31], v[12:15], v[44:47], v[28:31]
    ds_read_b64_tr_b16 v[40:41], v6 offset:6144
    ds_read_b64_tr_b16 v[42:43], v6 offset:6400
    s_waitcnt lgkmcnt(4)
    v_mfma_f32_16x16x32_bf16 v[16:19], v[32:35], v[32:35], v[16:19]
    v_mfma_f32_16x16x32_bf16 v[20:23], v[12:15], v[32:35], v[20:23]
    ds_read_b64_tr_b16 v[44:45], v6 offset:6176
    ds_read_b64_tr_b16 v[46:47], v6 offset:6432
    s_waitcnt lgkmcnt(4)
    v_mfma_f32_16x16x32_bf16 v[24:27], v[36:39], v[36:39], v[24:27]
    v_mfma_f32_16x16x32_bf16 v[28:31], v[12:15], v[36:39], v[28:31]
    ds_read_b64_tr_b16 v[32:33], v6 offset:8192
    ds_read_b64_tr_b16 v[34:35], v6 offset:8448
    s_waitcnt lgkmcnt(4)
    v_mfma_f32_16x16x32_bf16 v[16:19], v[40:43], v[40:43], v[16:19]
    v_mfma_f32_16x16x32_bf16 v[20:23], v[12:15], v[40:43], v[20:23]
    ds_read_b64_tr_b16 v[36:37], v6 offset:8224
    ds_read_b64_tr_b16 v[38:39], v6 offset:8480
    s_waitcnt lgkmcnt(4)
    v_mfma_f32_16x16x32_bf16 v[24:27], v[44:47], v[44:47], v[24:27]
    v_mfma_f32_16x16x32_bf16 v[28:31], v[12:15], v[44:47], v[28:31]
    ds_read_b64_tr_b16 v[40:41], v6 offset:10240
    ds_read_b64_tr_b16 v[42:43], v6 offset:10496
    s_waitcnt lgkmcnt(4)
    v_mfma_f32_16x16x32_bf16 v[16:19], v[32:35], v[32:35], v[16:19]
    v_mfma_f32_16x16x32_bf16 v[20:23], v[12:15], v[32:35], v[20:23]
    ds_read_b64_tr_b16 v[44:45], v6 offset:10272
    ds_read_b64_tr_b16 v[46:47], v6 offset:10528
    s_waitcnt lgkmcnt(4)
    v_mfma_f32_16x16x32_bf16 v[24:27], v[36:39], v[36:39], v[24:27]
    v_mfma_f32_16x16x32_bf16 v[28:31], v[12:15], v[36:39], v[28:31]
    ds_read_b64_tr_b16 v[32:33], v6 offset:12288
    ds_read_b64_tr_b16 v[34:35], v6 offset:12544
    s_waitcnt lgkmcnt(4)
    v_mfma_f32_16x16x32_bf16 v[16:19], v[40:43], v[40:43], v[16:19]
    v_mfma_f32_16x16x32_bf16 v[20:23], v[12:15], v[40:43], v[20:23]
    ds_read_b64_tr_b16 v[36:37], v6 offset:12320
    ds_read_b64_tr_b16 v[38:39], v6 offset:12576
    s_waitcnt lgkmcnt(4)
    v_mfma_f32_16x16x32_bf16 v[24:27], v[44:47], v[44:47], v[24:27]
    v_mfma_f32_16x16x32_bf16 v[28:31], v[12:15], v[44:47], v[28:31]
    ds_read_b64_tr_b16 v[40:41], v6 offset:14336
    ds_read_b64_tr_b16 v[42:43], v6 offset:14592
    s_waitcnt lgkmcnt(4)
    v_mfma_f32_16x16x32_bf16 v[16:19], v[32:35], v[32:35], v[16:19]
    v_mfma_f32_16x16x32_bf16 v[20:23], v[12:15], v[32:35], v[20:23]
    ds_read_b64_tr_b16 v[44:45], v6 offset:14368
    ds_read_b64_tr_b16 v[46:47], v6 offset:14624
    s_waitcnt lgkmcnt(4)
    v_mfma_f32_16x16x32_bf16 v[24:27], v[36:39], v[36:39], v[24:27]
    v_mfma_f32_16x16x32_bf16 v[28:31], v[12:15], v[36:39], v[28:31]
    ds_read_b64_tr_b16 v[32:33], v6 offset:16384
    ds_read_b64_tr_b16 v[34:35], v6 offset:16640
    s_waitcnt lgkmcnt(4)
    v_mfma_f32_16x16x32_bf16 v[16:19], v[40:43], v[40:43], v[16:19]
    v_mfma_f32_16x16x32_bf16 v[20:23], v[12:15], v[40:43], v[20:23]
    ds_read_b64_tr_b16 v[36:37], v6 offset:16416
    ds_read_b64_tr_b16 v[38:39], v6 offset:16672
    s_waitcnt lgkmcnt(4)
    v_mfma_f32_16x16x32_bf16 v[24:27], v[44:47], v[44:47], v[24:27]
    v_mfma_f32_16x16x32_bf16 v[28:31], v[12:15], v[44:47], v[28:31]
    ds_read_b64_tr_b16 v[40:41], v6 offset:18432
    ds_read_b64_tr_b16 v[42:43], v6 offset:18688
    s_waitcnt lgkmcnt(4)
    v_mfma_f32_16x16x32_bf16 v[16:19], v[32:35], v[32:35], v[16:19]
    v_mfma_f32_16x16x32_bf16 v[20:23], v[12:15], v[32:35], v[20:23]
    ds_read_b64_tr_b16 v[44:45], v6 offset:18464
    ds_read_b64_tr_b16 v[46:47], v6 offset:18720
    s_waitcnt lgkmcnt(4)
    v_mfma_f32_16x16x32_bf16 v[24:27], v[36:39], v[36:39], v[24:27]
    v_mfma_f32_16x16x32_bf16 v[28:31], v[12:15], v[36:39], v[28:31]
    ds_read_b64_tr_b16 v[32:33], v6 offset:20480
    ds_read_b64_tr_b16 v[34:35], v6 offset:20736
    s_waitcnt lgkmcnt(4)
    v_mfma_f32_16x16x32_bf16 v[16:19], v[40:43], v[40:43], v[16:19]
    v_mfma_f32_16x16x32_bf16 v[20:23], v[12:15], v[40:43], v[20:23]
    ds_read_b64_tr_b16 v[36:37], v6 offset:20512
    ds_read_b64_tr_b16 v[38:39], v6 offset:20768
    s_waitcnt lgkmcnt(4)
    v_mfma_f32_16x16x32_bf16 v[24:27], v[44:47], v[44:47], v[24:27]
    v_mfma_f32_16x16x32_bf16 v[28:31], v[12:15], v[44:47], v[28:31]
    ds_read_b64_tr_b16 v[40:41], v6 offset:22528
    ds_read_b64_tr_b16 v[42:43], v6 offset:22784
    s_waitcnt lgkmcnt(4)
    v_mfma_f32_16x16x32_bf16 v[16:19], v[32:35], v[32:35], v[16:19]
    v_mfma_f32_16x16x32_bf16 v[20:23], v[12:15], v[32:35], v[20:23]
    ds_read_b64_tr_b16 v[44:45], v6 offset:22560
    ds_read_b64_tr_b16 v[46:47], v6 offset:22816
    s_waitcnt lgkmcnt(4)
    v_mfma_f32_16x16x32_bf16 v[24:27], v[36:39], v[36:39], v[24:27]
    v_mfma_f32_16x16x32_bf16 v[28:31], v[12:15], v[36:39], v[28:31]
    ds_read_b64_tr_b16 v[32:33], v6 offset:24576
    ds_read_b64_tr_b16 v[34:35], v6 offset:24832
    s_waitcnt lgkmcnt(4)
    v_mfma_f32_16x16x32_bf16 v[16:19], v[40:43], v[40:43], v[16:19]
    v_mfma_f32_16x16x32_bf16 v[20:23], v[12:15], v[40:43], v[20:23]
    ds_read_b64_tr_b16 v[36:37], v6 offset:24608
    ds_read_b64_tr_b16 v[38:39], v6 offset:24864
    s_waitcnt lgkmcnt(4)
    v_mfma_f32_16x16x32_bf16 v[24:27], v[44:47], v[44:47], v[24:27]
    v_mfma_f32_16x16x32_bf16 v[28:31], v[12:15], v[44:47], v[28:31]
    ds_read_b64_tr_b16 v[40:41], v6 offset:26624
    ds_read_b64_tr_b16 v[42:43], v6 offset:26880
    s_waitcnt lgkmcnt(4)
    v_mfma_f32_16x16x32_bf16 v[16:19], v[32:35], v[32:35], v[16:19]
    v_mfma_f32_16x16x32_bf16 v[20:23], v[12:15], v[32:35], v[20:23]
    ds_read_b64_tr_b16 v[44:45], v6 offset:26656
    ds_read_b64_tr_b16 v[46:47], v6 offset:26912
    s_waitcnt lgkmcnt(4)
    v_mfma_f32_16x16x32_bf16 v[24:27], v[36:39], v[36:39], v[24:27]
    v_mfma_f32_16x16x32_bf16 v[28:31], v[12:15], v[36:39], v[28:31]
    ds_read_b64_tr_b16 v[32:33], v6 offset:28672
    ds_read_b64_tr_b16 v[34:35], v6 offset:28928
    s_waitcnt lgkmcnt(4)
    v_mfma_f32_16x16x32_bf16 v[16:19], v[40:43], v[40:43], v[16:19]
    v_mfma_f32_16x16x32_bf16 v[20:23], v[12:15], v[40:43], v[20:23]
    ds_read_b64_tr_b16 v[36:37], v6 offset:28704
    ds_read_b64_tr_b16 v[38:39], v6 offset:28960
    s_waitcnt lgkmcnt(4)
    v_mfma_f32_16x16x32_bf16 v[24:27], v[44:47], v[44:47], v[24:27]
    v_mfma_f32_16x16x32_bf16 v[28:31], v[12:15], v[44:47], v[28:31]
    ds_read_b64_tr_b16 v[40:41], v6 offset:30720
    ds_read_b64_tr_b16 v[42:43], v6 offset:30976
    s_waitcnt lgkmcnt(4)
    v_mfma_f32_16x16x32_bf16 v[16:19], v[32:35], v[32:35], v[16:19]
    v_mfma_f32_16x16x32_bf16 v[20:23], v[12:15], v[32:35], v[20:23]
    ds_read_b64_tr_b16 v[44:45], v6 offset:30752
    ds_read_b64_tr_b16 v[46:47], v6 offset:31008
    s_waitcnt lgkmcnt(4)
    v_mfma_f32_16x16x32_bf16 v[24:27], v[36:39], v[36:39], v[24:27]
    v_mfma_f32_16x16x32_bf16 v[28:31], v[12:15], v[36:39], v[28:31]
    s_waitcnt lgkmcnt(2)
    v_mfma_f32_16x16x32_bf16 v[16:19], v[40:43], v[40:43], v[16:19]
    v_mfma_f32_16x16x32_bf16 v[20:23], v[12:15], v[40:43], v[20:23]
    s_waitcnt lgkmcnt(0)
    v_mfma_f32_16x16x32_bf16 v[24:27], v[44:47], v[44:47], v[24:27]
    v_mfma_f32_16x16x32_bf16 v[28:31], v[12:15], v[44:47], v[28:31]
    s_nop 15
    v_cndmask_b32 v16, v16, v17, s[16:17]
    v_cndmask_b32 v16, v16, v18, s[18:19]
    v_cndmask_b32 v16, v16, v19, s[20:21]
    v_cndmask_b32 v24, v24, v25, s[16:17]
    v_cndmask_b32 v24, v24, v26, s[18:19]
    v_cndmask_b32 v24, v24, v27, s[20:21]
    v_mul_f32 v20, 0x3b000000, v20
    v_mul_f32 v16, 0x3b000000, v16
    v_mul_f32 v28, 0x3b000000, v28
    v_mul_f32 v24, 0x3b000000, v24
    v_fma_f32 v16, -v20, v20, v16
    v_max_f32 v16, 0, v16
    v_fma_f32 v24, -v28, v28, v24
    v_max_f32 v24, 0, v24
    v_cvt_pk_bf16_f32 v16, v16, v16
    v_lshlrev_b32 v16, 16, v16
    v_cvt_pk_bf16_f32 v24, v24, v24
    v_lshlrev_b32 v24, 16, v24
    v_add_f32 v16, 0x3727c5ac, v16
    v_add_f32 v24, 0x3727c5ac, v24
    v_cvt_pk_bf16_f32 v16, v16, v16
    v_lshlrev_b32 v16, 16, v16
    v_cvt_pk_bf16_f32 v24, v24, v24
    v_lshlrev_b32 v24, 16, v24
    v_sqrt_f32 v16, v16
    v_sqrt_f32 v24, v24
    s_nop 0
    v_cvt_pk_bf16_f32 v16, v16, v16
    v_lshlrev_b32 v16, 16, v16
    v_cvt_pk_bf16_f32 v24, v24, v24
    v_lshlrev_b32 v24, 16, v24
    v_rcp_f32 v22, v16
    v_cvt_pk_bf16_f32 v21, -v20, v16
    v_cvt_pk_bf16_f32 v20, -v20, -v20
    v_rcp_f32 v30, v24
    v_cvt_pk_bf16_f32 v29, -v28, v24
    v_cvt_pk_bf16_f32 v28, -v28, -v28
    s_mov_b64 exec, s[62:63]
    ds_write_b128 v10, v[20:23] offset:512
    ds_write_b128 v10, v[28:31] offset:768
    s_mov_b64 exec, -1
    v_mov_b32 v4, 136368
    v_mov_b32 v5, 2
    ds_write_b32 v4, v5
    s_setprio 0
    buffer_load_dwordx4 v[160:163], v2, s[12:15], s57 offen offset:2048 sc1
    buffer_load_dwordx4 v[164:167], v2, s[12:15], s57 offen offset:3072 sc1
    s_add_u32 s57, s57, 4096
    buffer_load_dwordx4 v[168:171], v2, s[12:15], s57 offen offset:0 sc1
    buffer_load_dwordx4 v[172:175], v2, s[12:15], s57 offen offset:1024 sc1
    buffer_load_dwordx4 v[176:179], v2, s[12:15], s57 offen offset:2048 sc1
    buffer_load_dwordx4 v[180:183], v2, s[12:15], s57 offen offset:3072 sc1
    s_add_u32 s57, s57, 4096
    v_and_b32 v4, 3, v1
    v_lshlrev_b32 v4, 3, v4
    v_lshrrev_b32 v4, v4, s31
    v_bfe_u32 v5, v4, 0, 1
    v_lshlrev_b32 v5, 15, v5
    v_lshrrev_b32 v124, 1, v4
    v_lshl_or_b32 v124, v124, 31, v5
    v_bfe_u32 v5, v4, 2, 1
    v_lshlrev_b32 v5, 15, v5
    v_lshrrev_b32 v125, 3, v4
    v_lshl_or_b32 v125, v125, 31, v5
    v_bfe_u32 v5, v4, 4, 1
    v_lshlrev_b32 v5, 15, v5
    v_lshrrev_b32 v126, 5, v4
    v_lshl_or_b32 v126, v126, 31, v5
    v_bfe_u32 v5, v4, 6, 1
    v_lshlrev_b32 v5, 15, v5
    v_lshrrev_b32 v127, 7, v4
    v_lshl_or_b32 v127, v127, 31, v5
sequential_preLN__ssm_conv_s4__dense_activation_squared_relu__prompt_kernel_g24:
    s_mul_i32 s33, s52, 114688
    s_mul_i32 s34, s3, 14336
    s_add_u32 s33, s33, s34
    s_add_u32 s33, s33, 0x800000
    s_add_u32 s16, s98, s33
    s_addc_u32 s17, s99, 0
    s_movk_i32 s18, 0x3800
    s_mov_b32 s19, 0x00020000
    s_mov_b32 s4, 0
    s_movk_i32 s5, 4096
    s_movk_i32 s6, 8192
    s_movk_i32 s7, 12288
    s_lshl_b32 s34, s53, 2
    s_add_u32 s34, s34, s27
    s_lshl_b32 s35, s45, 2
    s_sub_u32 s34, s34, s35
    s_and_b32 s34, s34, 31
    s_lshl_b32 s34, s34, 10
    s_mov_b32 s31, 0
    s_mov_b32 s59, 0x80008000
    buffer_load_dwordx4 v[216:219], v2, s[16:19], s6 offen offset:0 sc1
    buffer_load_dwordx4 v[220:223], v2, s[16:19], s6 offen offset:1024 sc1
    buffer_load_dwordx4 v[224:227], v2, s[16:19], s6 offen offset:2048 sc1
    buffer_load_dwordx4 v[228:231], v2, s[16:19], s6 offen offset:3072 sc1
    buffer_load_dwordx4 v[232:235], v2, s[16:19], s7 offen offset:0 sc1
    buffer_load_dwordx4 v[236:239], v2, s[16:19], s7 offen offset:1024 sc1
    buffer_load_dwordx4 v[240:243], v2, s[16:19], s4 offen offset:0 sc1
    buffer_load_dwordx4 v[244:247], v2, s[16:19], s4 offen offset:1024 sc1
    buffer_load_dwordx4 v[248:251], v2, s[16:19], s4 offen offset:2048 sc1
    buffer_load_dwordx4 v[252:255], v2, s[16:19], s4 offen offset:3072 sc1
    buffer_load_dwordx4 v[120:123], v2, s[16:19], s5 offen offset:0 sc1
    buffer_load_dwordx4 v[56:59], v2, s[16:19], s5 offen offset:1024 sc1
    buffer_load_dwordx4 v[60:63], v2, s[16:19], s5 offen offset:2048 sc1
    v_lshrrev_b32 v5, 5, v1
    v_lshl_add_u32 v3, v5, 3, v8
    v_lshl_add_u32 v3, v3, 6, v9
    v_and_b32 v7, 16, v1
    v_lshl_add_u32 v3, v7, 1, v3
    v_add_u32 v3, s34, v3
    ds_read_b64_tr_b16 v[12:13], v3 offset:33280
    ds_read_b64_tr_b16 v[14:15], v3 offset:33536
    s_add_u32 s20, s16, 0x380000
    s_addc_u32 s21, s17, 0
    s_mov_b32 s22, s18
    s_mov_b32 s23, 0x00020000
    v_and_b32 v9, 31, v1
    v_lshlrev_b32 v6, 3, v5
    v_sub_u32 v6, v9, v6
    s_lshl_b32 s34, s24, 4
    v_subrev_u32 v6, s34, v6
    v_and_b32 v4, 1, v6
    v_lshlrev_b32 v4, 4, v4
    v_mov_b32 v10, 0x3f80
    v_lshlrev_b32 v4, v4, v10
    v_ashrrev_i32 v6, 1, v6
    v_cmp_eq_u32 vcc, 0, v6
    s_lshr_b32 s32, s24, 1
    s_and_b32 s33, s24, 1
    v_cndmask_b32 v48, 0, v4, vcc
    v_cmp_eq_u32 vcc, 1, v6
    s_lshl_b32 s34, s32, 10
    s_lshl_b32 s35, s33, 3
    v_cndmask_b32 v49, 0, v4, vcc
    v_cmp_eq_u32 vcc, 2, v6
    s_add_u32 s34, s34, s35
    s_nop 0
    v_cndmask_b32 v50, 0, v4, vcc
    v_cmp_eq_u32 vcc, 3, v6
    s_mul_i32 s30, s24, 8224
    s_nop 0
    v_cndmask_b32 v51, 0, v4, vcc
    v_cmp_eq_u32 vcc, -16, v6
    s_lshl_b32 s32, s32, 3
    s_lshl_b32 s33, s33, 1
    v_cndmask_b32 v52, 0, v4, vcc
    v_cmp_eq_u32 vcc, -15, v6
    s_add_u32 s32, s32, s33
    s_lshl_b32 s33, s53, 7
    v_cndmask_b32 v53, 0, v4, vcc
    v_cmp_eq_u32 vcc, -14, v6
    s_lshl_b32 s35, s52, 15
    s_add_u32 s33, s33, s35
    v_cndmask_b32 v54, 0, v4, vcc
    v_cmp_eq_u32 vcc, -13, v6
    s_nop 1
    v_cndmask_b32 v55, 0, v4, vcc
    s_waitcnt lgkmcnt(0)
    s_nop 0
    v_mfma_f32_32x32x16_bf16 v[16:31], v[12:15], v[48:51], 0
    v_mfma_f32_32x32x16_bf16 v[32:47], v[12:15], v[52:55], 0
    ds_read_b64_tr_b16 v[12:13], v3 offset:0
    ds_read_b64_tr_b16 v[14:15], v3 offset:256
    v_and_b32 v6, 15, v1
    v_lshlrev_b32 v6, 5, v6
    v_lshl_add_u32 v6, v5, 9, v6
    v_mul_u32_u24 v7, 257, v7
    v_add3_u32 v6, v6, v7, s34
    v_add_u32 v7, s30, v2
    v_add_u32 v3, 66048, v6
    v_lshl_add_u32 v8, v5, 2, s32
    v_lshlrev_b32 v8, 10, v8
    v_lshl_add_u32 v8, v9, 2, v8
    v_add_u32 v8, s33, v8
    v_lshlrev_b32 v10, 16, v11
    v_and_b32 v11, s55, v11
    v_add_u32 v9, 66048, v7
    s_waitcnt lgkmcnt(0)
    v_mfma_f32_32x32x16_bf16 v[184:199], v[12:15], v[48:51], 0
    v_mfma_f32_32x32x16_bf16 v[200:215], v[12:15], v[52:55], 0
    buffer_load_dwordx4 v[48:51], v2, s[16:19], s5 offen offset:3072 sc1
    v_mov_b32 v52, 136372
    v_mov_b32 v53, 1
    s_mov_b64 exec, 1
    ds_add_u32 v52, v53
    s_mov_b64 exec, -1
    s_waitcnt vmcnt(13)
    v_xor_b32 v216, v216, v124
    v_xor_b32 v217, v217, v125
    v_xor_b32 v218, v218, v126
    v_xor_b32 v219, v219, v127
    v_or3_b32 v4, v216, v217, v218
    v_or_b32 v4, v4, v219
    s_waitcnt vmcnt(12)
    v_xor_b32 v220, v220, v124
    v_xor_b32 v221, v221, v125
    v_xor_b32 v222, v222, v126
    v_xor_b32 v223, v223, v127
    v_or3_b32 v4, v220, v221, v4
    v_or3_b32 v4, v222, v223, v4
    s_waitcnt vmcnt(11)
    v_xor_b32 v224, v224, v124
    v_xor_b32 v225, v225, v125
    v_xor_b32 v226, v226, v126
    v_xor_b32 v227, v227, v127
    v_or3_b32 v4, v224, v225, v4
    v_or3_b32 v4, v226, v227, v4
    s_waitcnt vmcnt(10)
    v_xor_b32 v228, v228, v124
    v_xor_b32 v229, v229, v125
    v_xor_b32 v230, v230, v126
    v_xor_b32 v231, v231, v127
    v_or3_b32 v4, v228, v229, v4
    v_or3_b32 v4, v230, v231, v4
    v_and_b32 v4, s59, v4
    v_cmp_ne_u32 vcc, 0, v4
    s_cbranch_vccnz sequential_preLN__ssm_conv_s4__dense_activation_squared_relu__prompt_kernel_hr26
sequential_preLN__ssm_conv_s4__dense_activation_squared_relu__prompt_kernel_hr26b:
    v_mfma_f32_32x32x16_bf16 v[16:31], v[216:219], v[136:139], v[16:31]
    s_waitcnt vmcnt(9)
    v_xor_b32 v232, v232, v124
    v_xor_b32 v233, v233, v125
    v_xor_b32 v234, v234, v126
    v_xor_b32 v235, v235, v127
    v_or3_b32 v4, v232, v233, v234
    v_or_b32 v4, v4, v235
    v_mfma_f32_32x32x16_bf16 v[32:47], v[216:219], v[140:143], v[32:47]
    v_mfma_f32_32x32x16_bf16 v[16:31], v[220:223], v[144:147], v[16:31]
    s_waitcnt vmcnt(8)
    v_xor_b32 v236, v236, v124
    v_xor_b32 v237, v237, v125
    v_xor_b32 v238, v238, v126
    v_xor_b32 v239, v239, v127
    v_or3_b32 v4, v236, v237, v4
    v_or3_b32 v4, v238, v239, v4
    v_mfma_f32_32x32x16_bf16 v[32:47], v[220:223], v[148:151], v[32:47]
    v_mfma_f32_32x32x16_bf16 v[16:31], v[224:227], v[152:155], v[16:31]
    s_waitcnt vmcnt(7)
    v_xor_b32 v240, v240, v124
    v_xor_b32 v241, v241, v125
    v_xor_b32 v242, v242, v126
    v_xor_b32 v243, v243, v127
    v_or3_b32 v4, v240, v241, v4
    v_or3_b32 v4, v242, v243, v4
    v_mfma_f32_32x32x16_bf16 v[32:47], v[224:227], v[156:159], v[32:47]
    v_mfma_f32_32x32x16_bf16 v[16:31], v[228:231], v[160:163], v[16:31]
    s_waitcnt vmcnt(6)
    v_xor_b32 v244, v244, v124
    v_xor_b32 v245, v245, v125
    v_xor_b32 v246, v246, v126
    v_xor_b32 v247, v247, v127
    v_or3_b32 v4, v244, v245, v4
    v_or3_b32 v4, v246, v247, v4
    v_and_b32 v4, s59, v4
    v_cmp_ne_u32 vcc, 0, v4
    s_cbranch_vccnz sequential_preLN__ssm_conv_s4__dense_activation_squared_relu__prompt_kernel_hr27
sequential_preLN__ssm_conv_s4__dense_activation_squared_relu__prompt_kernel_hr27b:
    v_mfma_f32_32x32x16_bf16 v[32:47], v[228:231], v[164:167], v[32:47]
    v_mfma_f32_32x32x16_bf16 v[16:31], v[232:235], v[168:171], v[16:31]
    s_waitcnt vmcnt(5)
    v_xor_b32 v248, v248, v124
    v_xor_b32 v249, v249, v125
    v_xor_b32 v250, v250, v126
    v_xor_b32 v251, v251, v127
    v_or3_b32 v4, v248, v249, v250
    v_or_b32 v4, v4, v251
    v_mfma_f32_32x32x16_bf16 v[32:47], v[232:235], v[172:175], v[32:47]
    v_mfma_f32_32x32x16_bf16 v[16:31], v[236:239], v[176:179], v[16:31]
    s_waitcnt vmcnt(4)
    v_xor_b32 v252, v252, v124
    v_xor_b32 v253, v253, v125
    v_xor_b32 v254, v254, v126
    v_xor_b32 v255, v255, v127
    v_or3_b32 v4, v252, v253, v4
    v_or3_b32 v4, v254, v255, v4
    v_mfma_f32_32x32x16_bf16 v[32:47], v[236:239], v[180:183], v[32:47]
    v_mfma_f32_32x32x16_bf16 v[16:31], v[240:243], v[64:67], v[16:31]
    s_waitcnt vmcnt(3)
    v_xor_b32 v120, v120, v124
    v_xor_b32 v121, v121, v125
    v_xor_b32 v122, v122, v126
    v_xor_b32 v123, v123, v127
    v_or3_b32 v4, v120, v121, v4
    v_or3_b32 v4, v122, v123, v4
    v_mfma_f32_32x32x16_bf16 v[32:47], v[240:243], v[68:71], v[32:47]
    buffer_load_dwordx4 v[216:219], v2, s[20:23], s6 offen offset:0 sc1
    buffer_load_dwordx4 v[220:223], v2, s[20:23], s6 offen offset:1024 sc1
    buffer_load_dwordx4 v[224:227], v2, s[20:23], s6 offen offset:2048 sc1
    buffer_load_dwordx4 v[228:231], v2, s[20:23], s6 offen offset:3072 sc1
    buffer_load_dwordx4 v[232:235], v2, s[20:23], s7 offen offset:0 sc1
    buffer_load_dwordx4 v[236:239], v2, s[20:23], s7 offen offset:1024 sc1
    v_mfma_f32_32x32x16_bf16 v[16:31], v[244:247], v[72:75], v[16:31]
    s_waitcnt vmcnt(8)
    v_xor_b32 v56, v56, v124
    v_xor_b32 v57, v57, v125
    v_xor_b32 v58, v58, v126
    v_xor_b32 v59, v59, v127
    v_or3_b32 v4, v56, v57, v4
    v_or3_b32 v4, v58, v59, v4
    v_and_b32 v4, s59, v4
    v_cmp_ne_u32 vcc, 0, v4
    s_cbranch_vccnz sequential_preLN__ssm_conv_s4__dense_activation_squared_relu__prompt_kernel_hr28
sequential_preLN__ssm_conv_s4__dense_activation_squared_relu__prompt_kernel_hr28b:
    v_mfma_f32_32x32x16_bf16 v[32:47], v[244:247], v[76:79], v[32:47]
    v_mfma_f32_32x32x16_bf16 v[16:31], v[248:251], v[80:83], v[16:31]
    s_waitcnt vmcnt(7)
    v_xor_b32 v60, v60, v124
    v_xor_b32 v61, v61, v125
    v_xor_b32 v62, v62, v126
    v_xor_b32 v63, v63, v127
    v_or3_b32 v4, v60, v61, v62
    v_or_b32 v4, v4, v63
    v_mfma_f32_32x32x16_bf16 v[32:47], v[248:251], v[84:87], v[32:47]
    v_mfma_f32_32x32x16_bf16 v[16:31], v[252:255], v[88:91], v[16:31]
    s_waitcnt vmcnt(6)
    v_xor_b32 v48, v48, v124
    v_xor_b32 v49, v49, v125
    v_xor_b32 v50, v50, v126
    v_xor_b32 v51, v51, v127
    v_or3_b32 v4, v48, v49, v4
    v_or3_b32 v4, v50, v51, v4
    v_mfma_f32_32x32x16_bf16 v[32:47], v[252:255], v[92:95], v[32:47]
    v_mfma_f32_32x32x16_bf16 v[16:31], v[120:123], v[96:99], v[16:31]
    s_waitcnt vmcnt(5)
    v_xor_b32 v216, v216, v124
    v_xor_b32 v217, v217, v125
    v_xor_b32 v218, v218, v126
    v_xor_b32 v219, v219, v127
    v_or3_b32 v4, v216, v217, v4
    v_or3_b32 v4, v218, v219, v4
    v_mfma_f32_32x32x16_bf16 v[32:47], v[120:123], v[100:103], v[32:47]
    v_mfma_f32_32x32x16_bf16 v[16:31], v[56:59], v[104:107], v[16:31]
    s_waitcnt vmcnt(4)
    v_xor_b32 v220, v220, v124
    v_xor_b32 v221, v221, v125
    v_xor_b32 v222, v222, v126
    v_xor_b32 v223, v223, v127
    v_or3_b32 v4, v220, v221, v4
    v_or3_b32 v4, v222, v223, v4
    v_and_b32 v4, s59, v4
    v_cmp_ne_u32 vcc, 0, v4
    s_cbranch_vccnz sequential_preLN__ssm_conv_s4__dense_activation_squared_relu__prompt_kernel_hr29
sequential_preLN__ssm_conv_s4__dense_activation_squared_relu__prompt_kernel_hr29b:
    v_mfma_f32_32x32x16_bf16 v[32:47], v[56:59], v[108:111], v[32:47]
    v_mfma_f32_32x32x16_bf16 v[16:31], v[60:63], v[112:115], v[16:31]
    s_waitcnt vmcnt(3)
    v_xor_b32 v224, v224, v124
    v_xor_b32 v225, v225, v125
    v_xor_b32 v226, v226, v126
    v_xor_b32 v227, v227, v127
    v_or3_b32 v4, v224, v225, v226
    v_or_b32 v4, v4, v227
    v_mfma_f32_32x32x16_bf16 v[32:47], v[60:63], v[116:119], v[32:47]
    buffer_load_dwordx4 v[240:243], v2, s[20:23], s4 offen offset:0 sc1
    buffer_load_dwordx4 v[244:247], v2, s[20:23], s4 offen offset:1024 sc1
    buffer_load_dwordx4 v[248:251], v2, s[20:23], s4 offen offset:2048 sc1
    buffer_load_dwordx4 v[252:255], v2, s[20:23], s4 offen offset:3072 sc1
    buffer_load_dwordx4 v[120:123], v2, s[20:23], s5 offen offset:0 sc1
    buffer_load_dwordx4 v[56:59], v2, s[20:23], s5 offen offset:1024 sc1
    buffer_load_dwordx4 v[60:63], v2, s[20:23], s5 offen offset:2048 sc1
    v_mfma_f32_32x32x16_bf16 v[16:31], v[48:51], v[128:131], v[16:31]
    s_waitcnt vmcnt(9)
    v_xor_b32 v228, v228, v124
    v_xor_b32 v229, v229, v125
    v_xor_b32 v230, v230, v126
    v_xor_b32 v231, v231, v127
    v_or3_b32 v4, v228, v229, v4
    v_or3_b32 v4, v230, v231, v4
    v_mfma_f32_32x32x16_bf16 v[32:47], v[48:51], v[132:135], v[32:47]
    buffer_load_dwordx4 v[48:51], v2, s[20:23], s5 offen offset:3072 sc1
    v_mfma_f32_32x32x16_bf16 v[184:199], v[216:219], v[136:139], v[184:199]
    s_waitcnt vmcnt(9)
    v_xor_b32 v232, v232, v124
    v_xor_b32 v233, v233, v125
    v_xor_b32 v234, v234, v126
    v_xor_b32 v235, v235, v127
    v_or3_b32 v4, v232, v233, v4
    v_or3_b32 v4, v234, v235, v4
    v_mfma_f32_32x32x16_bf16 v[200:215], v[216:219], v[140:143], v[200:215]
    v_mfma_f32_32x32x16_bf16 v[184:199], v[220:223], v[144:147], v[184:199]
    s_waitcnt vmcnt(8)
    v_xor_b32 v236, v236, v124
    v_xor_b32 v237, v237, v125
    v_xor_b32 v238, v238, v126
    v_xor_b32 v239, v239, v127
    v_or3_b32 v4, v236, v237, v4
    v_or3_b32 v4, v238, v239, v4
    v_and_b32 v4, s59, v4
    v_cmp_ne_u32 vcc, 0, v4
    s_cbranch_vccnz sequential_preLN__ssm_conv_s4__dense_activation_squared_relu__prompt_kernel_hr30
sequential_preLN__ssm_conv_s4__dense_activation_squared_relu__prompt_kernel_hr30b:
    v_mfma_f32_32x32x16_bf16 v[200:215], v[220:223], v[148:151], v[200:215]
    ds_write_b128 v9, v[16:19] offset:0
    ds_write_b128 v9, v[20:23] offset:1024
    v_mfma_f32_32x32x16_bf16 v[184:199], v[224:227], v[152:155], v[184:199]
    s_waitcnt vmcnt(7)
    v_xor_b32 v240, v240, v124
    v_xor_b32 v241, v241, v125
    v_xor_b32 v242, v242, v126
    v_xor_b32 v243, v243, v127
    v_or3_b32 v4, v240, v241, v242
    v_or_b32 v4, v4, v243
    v_mfma_f32_32x32x16_bf16 v[200:215], v[224:227], v[156:159], v[200:215]
    ds_write_b128 v9, v[24:27] offset:2048
    ds_write_b128 v9, v[28:31] offset:3072
    v_mfma_f32_32x32x16_bf16 v[184:199], v[228:231], v[160:163], v[184:199]
    s_waitcnt vmcnt(6)
    v_xor_b32 v244, v244, v124
    v_xor_b32 v245, v245, v125
    v_xor_b32 v246, v246, v126
    v_xor_b32 v247, v247, v127
    v_or3_b32 v4, v244, v245, v4
    v_or3_b32 v4, v246, v247, v4
    v_mfma_f32_32x32x16_bf16 v[200:215], v[228:231], v[164:167], v[200:215]
    ds_write_b128 v9, v[32:35] offset:4112
    ds_write_b128 v9, v[36:39] offset:5136
    v_mfma_f32_32x32x16_bf16 v[184:199], v[232:235], v[168:171], v[184:199]
    s_waitcnt vmcnt(5)
    v_xor_b32 v248, v248, v124
    v_xor_b32 v249, v249, v125
    v_xor_b32 v250, v250, v126
    v_xor_b32 v251, v251, v127
    v_or3_b32 v4, v248, v249, v4
    v_or3_b32 v4, v250, v251, v4
    v_mfma_f32_32x32x16_bf16 v[200:215], v[232:235], v[172:175], v[200:215]
    ds_write_b128 v9, v[40:43] offset:6160
    ds_write_b128 v9, v[44:47] offset:7184
    s_mov_b64 exec, 1
    ds_add_u32 v52, v53 offset:4
    s_mov_b64 exec, -1
    v_mfma_f32_32x32x16_bf16 v[184:199], v[236:239], v[176:179], v[184:199]
    s_waitcnt vmcnt(4)
    v_xor_b32 v252, v252, v124
    v_xor_b32 v253, v253, v125
    v_xor_b32 v254, v254, v126
    v_xor_b32 v255, v255, v127
    v_or3_b32 v4, v252, v253, v4
    v_or3_b32 v4, v254, v255, v4
    v_and_b32 v4, s59, v4
    v_cmp_ne_u32 vcc, 0, v4
    s_cbranch_vccnz sequential_preLN__ssm_conv_s4__dense_activation_squared_relu__prompt_kernel_hr31
sequential_preLN__ssm_conv_s4__dense_activation_squared_relu__prompt_kernel_hr31b:
    v_mfma_f32_32x32x16_bf16 v[200:215], v[236:239], v[180:183], v[200:215]
    v_mfma_f32_32x32x16_bf16 v[184:199], v[240:243], v[64:67], v[184:199]
    s_waitcnt vmcnt(3)
    v_xor_b32 v120, v120, v124
    v_xor_b32 v121, v121, v125
    v_xor_b32 v122, v122, v126
    v_xor_b32 v123, v123, v127
    v_or3_b32 v4, v120, v121, v122
    v_or_b32 v4, v4, v123
    v_mfma_f32_32x32x16_bf16 v[200:215], v[240:243], v[68:71], v[200:215]
    v_mfma_f32_32x32x16_bf16 v[184:199], v[244:247], v[72:75], v[184:199]
    s_waitcnt vmcnt(2)
    v_xor_b32 v56, v56, v124
    v_xor_b32 v57, v57, v125
    v_xor_b32 v58, v58, v126
    v_xor_b32 v59, v59, v127
    v_or3_b32 v4, v56, v57, v4
    v_or3_b32 v4, v58, v59, v4
    v_mfma_f32_32x32x16_bf16 v[200:215], v[244:247], v[76:79], v[200:215]
    v_mfma_f32_32x32x16_bf16 v[184:199], v[248:251], v[80:83], v[184:199]
    s_waitcnt vmcnt(1)
    v_xor_b32 v60, v60, v124
    v_xor_b32 v61, v61, v125
    v_xor_b32 v62, v62, v126
    v_xor_b32 v63, v63, v127
    v_or3_b32 v4, v60, v61, v4
    v_or3_b32 v4, v62, v63, v4
    v_mfma_f32_32x32x16_bf16 v[200:215], v[248:251], v[84:87], v[200:215]
    v_mfma_f32_32x32x16_bf16 v[184:199], v[252:255], v[88:91], v[184:199]
    s_waitcnt vmcnt(0)
    v_xor_b32 v48, v48, v124
    v_xor_b32 v49, v49, v125
    v_xor_b32 v50, v50, v126
    v_xor_b32 v51, v51, v127
    v_or3_b32 v4, v48, v49, v4
    v_or3_b32 v4, v50, v51, v4
    v_and_b32 v4, s59, v4
    v_cmp_ne_u32 vcc, 0, v4
    s_cbranch_vccnz sequential_preLN__ssm_conv_s4__dense_activation_squared_relu__prompt_kernel_hr32
sequential_preLN__ssm_conv_s4__dense_activation_squared_relu__prompt_kernel_hr32b:
    v_mfma_f32_32x32x16_bf16 v[200:215], v[252:255], v[92:95], v[200:215]
    v_mfma_f32_32x32x16_bf16 v[184:199], v[120:123], v[96:99], v[184:199]
    v_mfma_f32_32x32x16_bf16 v[200:215], v[120:123], v[100:103], v[200:215]
    v_mfma_f32_32x32x16_bf16 v[184:199], v[56:59], v[104:107], v[184:199]
    v_mfma_f32_32x32x16_bf16 v[200:215], v[56:59], v[108:111], v[200:215]
    ds_read_b32 v53, v52
    v_mfma_f32_32x32x16_bf16 v[184:199], v[60:63], v[112:115], v[184:199]
    v_mfma_f32_32x32x16_bf16 v[200:215], v[60:63], v[116:119], v[200:215]
    v_mfma_f32_32x32x16_bf16 v[184:199], v[48:51], v[128:131], v[184:199]
    v_mfma_f32_32x32x16_bf16 v[200:215], v[48:51], v[132:135], v[200:215]
    s_mov_b32 s32, 0
    s_waitcnt lgkmcnt(0)
sequential_preLN__ssm_conv_s4__dense_activation_squared_relu__prompt_kernel_tw33:
    v_cmp_gt_u32 vcc, 8, v53
    s_add_u32 s32, s32, 1
    s_cbranch_vccz sequential_preLN__ssm_conv_s4__dense_activation_squared_relu__prompt_kernel_tw33x
    s_cmp_gt_u32 s32, 600000
    s_cbranch_scc1 sequential_preLN__ssm_conv_s4__dense_activation_squared_relu__prompt_kernel_tw33x
    ds_read_b32 v53, v52
    s_waitcnt lgkmcnt(0)
    s_branch sequential_preLN__ssm_conv_s4__dense_activation_squared_relu__prompt_kernel_tw33
sequential_preLN__ssm_conv_s4__dense_activation_squared_relu__prompt_kernel_tw33x:
    s_nop 15
    s_nop 3
    ds_write_b128 v7, v[184:187] offset:0
    ds_write_b128 v7, v[188:191] offset:1024
    ds_write_b128 v7, v[192:195] offset:2048
    ds_write_b128 v7, v[196:199] offset:3072
    ds_write_b128 v7, v[200:203] offset:4112
    ds_write_b128 v7, v[204:207] offset:5136
    ds_write_b128 v7, v[208:211] offset:6160
    ds_write_b128 v7, v[212:215] offset:7184
    s_cmp_lt_u32 s24, 4
    s_cbranch_scc1 sequential_preLN__ssm_conv_s4__dense_activation_squared_relu__prompt_kernel_fk34
    s_mov_b32 s32, 0
    v_subrev_u32 v5, 2048, v3
    v_subrev_u32 v8, 16384, v8
sequential_preLN__ssm_conv_s4__dense_activation_squared_relu__prompt_kernel_aw35:
    s_sleep 1
    ds_read_b32 v53, v52 offset:4
    s_add_u32 s32, s32, 1
    s_waitcnt lgkmcnt(0)
    v_cmp_gt_u32 vcc, 8, v53
    s_cmp_gt_u32 s32, 600000
    s_cbranch_scc1 sequential_preLN__ssm_conv_s4__dense_activation_squared_relu__prompt_kernel_aw35x
    s_cbranch_vccnz sequential_preLN__ssm_conv_s4__dense_activation_squared_relu__prompt_kernel_aw35
sequential_preLN__ssm_conv_s4__dense_activation_squared_relu__prompt_kernel_aw35x:
    ds_read_b64 v[16:17], v3 offset:0
    ds_read_b64 v[18:19], v3 offset:16
    ds_read_b64 v[20:21], v3 offset:8224
    ds_read_b64 v[22:23], v3 offset:8240
    ds_read_b64 v[24:25], v3 offset:16448
    ds_read_b64 v[26:27], v3 offset:16464
    ds_read_b64 v[28:29], v3 offset:24672
    ds_read_b64 v[30:31], v3 offset:24688
    ds_read_b64 v[32:33], v3 offset:32896
    ds_read_b64 v[34:35], v3 offset:32912
    ds_read_b64 v[36:37], v3 offset:41120
    ds_read_b64 v[38:39], v3 offset:41136
    ds_read_b64 v[40:41], v3 offset:49344
    ds_read_b64 v[42:43], v3 offset:49360
    ds_read_b64 v[44:45], v3 offset:57568
    s_waitcnt lgkmcnt(13)
    v_add_f32 v16, v16, v10
    v_add_f32 v17, v17, v10
    v_add_f32 v18, v18, v11
    v_add_f32 v19, v19, v11
    ds_read_b64 v[46:47], v3 offset:57584
    ds_read_b64 v[96:97], v5 offset:0
    s_waitcnt lgkmcnt(13)
    v_add_f32 v16, v16, v20
    v_add_f32 v17, v17, v21
    v_add_f32 v18, v18, v22
    v_add_f32 v19, v19, v23
    ds_read_b64 v[98:99], v5 offset:16
    ds_read_b64 v[100:101], v5 offset:8224
    s_waitcnt lgkmcnt(13)
    v_add_f32 v16, v16, v24
    v_add_f32 v17, v17, v25
    v_add_f32 v18, v18, v26
    v_add_f32 v19, v19, v27
    ds_read_b64 v[102:103], v5 offset:8240
    ds_read_b64 v[104:105], v5 offset:16448
    s_waitcnt lgkmcnt(13)
    v_add_f32 v16, v16, v28
    v_add_f32 v17, v17, v29
    v_add_f32 v18, v18, v30
    v_add_f32 v19, v19, v31
    ds_read_b64 v[106:107], v5 offset:16464
    ds_read_b64 v[108:109], v5 offset:24672
    s_waitcnt lgkmcnt(13)
    v_add_f32 v16, v16, v32
    v_add_f32 v17, v17, v33
    v_add_f32 v18, v18, v34
    v_add_f32 v19, v19, v35
    ds_read_b64 v[110:111], v5 offset:24688
    ds_read_b64 v[112:113], v5 offset:32896
    s_waitcnt lgkmcnt(13)
    v_add_f32 v16, v16, v36
    v_add_f32 v17, v17, v37
    v_add_f32 v18, v18, v38
    v_add_f32 v19, v19, v39
    ds_read_b64 v[114:115], v5 offset:32912
    ds_read_b64 v[116:117], v5 offset:41120
    s_waitcnt lgkmcnt(13)
    v_add_f32 v16, v16, v40
    v_add_f32 v17, v17, v41
    v_add_f32 v18, v18, v42
    v_add_f32 v19, v19, v43
    ds_read_b64 v[118:119], v5 offset:41136
    ds_read_b64 v[128:129], v5 offset:49344
    s_waitcnt lgkmcnt(13)
    v_add_f32 v16, v16, v44
    v_add_f32 v17, v17, v45
    v_add_f32 v18, v18, v46
    v_add_f32 v19, v19, v47
    ds_read_b64 v[130:131], v5 offset:49360
    ds_read_b64 v[132:133], v5 offset:57568
    v_cvt_pk_bf16_f32 v20, v16, v18
    v_cvt_pk_bf16_f32 v21, v17, v19
    s_mov_b32 s34, 0x4000
    buffer_store_dword v20, v8, s[40:43], s34 offen
    buffer_store_dword v21, v8, s[40:43], s34 offen offset:1024
    s_waitcnt lgkmcnt(13)
    v_add_f32 v96, v96, v10
    v_add_f32 v97, v97, v10
    v_add_f32 v98, v98, v11
    v_add_f32 v99, v99, v11
    ds_read_b64 v[134:135], v5 offset:57584
    s_waitcnt lgkmcnt(12)
    v_add_f32 v96, v96, v100
    v_add_f32 v97, v97, v101
    v_add_f32 v98, v98, v102
    v_add_f32 v99, v99, v103
    s_waitcnt lgkmcnt(10)
    v_add_f32 v96, v96, v104
    v_add_f32 v97, v97, v105
    v_add_f32 v98, v98, v106
    v_add_f32 v99, v99, v107
    s_waitcnt lgkmcnt(8)
    v_add_f32 v96, v96, v108
    v_add_f32 v97, v97, v109
    v_add_f32 v98, v98, v110
    v_add_f32 v99, v99, v111
    s_waitcnt lgkmcnt(6)
    v_add_f32 v96, v96, v112
    v_add_f32 v97, v97, v113
    v_add_f32 v98, v98, v114
    v_add_f32 v99, v99, v115
    s_waitcnt lgkmcnt(4)
    v_add_f32 v96, v96, v116
    v_add_f32 v97, v97, v117
    v_add_f32 v98, v98, v118
    v_add_f32 v99, v99, v119
    s_waitcnt lgkmcnt(2)
    v_add_f32 v96, v96, v128
    v_add_f32 v97, v97, v129
    v_add_f32 v98, v98, v130
    v_add_f32 v99, v99, v131
    s_waitcnt lgkmcnt(0)
    v_add_f32 v96, v96, v132
    v_add_f32 v97, v97, v133
    v_add_f32 v98, v98, v134
    v_add_f32 v99, v99, v135
    v_cvt_pk_bf16_f32 v100, v96, v98
    v_cvt_pk_bf16_f32 v101, v97, v99
    s_mov_b32 s34, 0x0
    buffer_store_dword v100, v8, s[40:43], s34 offen
    buffer_store_dword v101, v8, s[40:43], s34 offen offset:1024
    v_add_u32 v8, 16384, v8
sequential_preLN__ssm_conv_s4__dense_activation_squared_relu__prompt_kernel_fk34:
    s_waitcnt lgkmcnt(0)
    s_barrier
    ds_read_b64 v[64:65], v6 offset:0
    ds_read_b64 v[66:67], v6 offset:16
    ds_read_b64 v[68:69], v6 offset:8224
    ds_read_b64 v[70:71], v6 offset:8240
    ds_read_b64 v[72:73], v6 offset:16448
    ds_read_b64 v[74:75], v6 offset:16464
    ds_read_b64 v[76:77], v6 offset:24672
    ds_read_b64 v[78:79], v6 offset:24688
    ds_read_b64 v[80:81], v6 offset:32896
    ds_read_b64 v[82:83], v6 offset:32912
    ds_read_b64 v[84:85], v6 offset:41120
    ds_read_b64 v[86:87], v6 offset:41136
    ds_read_b64 v[88:89], v6 offset:49344
    ds_read_b64 v[90:91], v6 offset:49360
    ds_read_b64 v[92:93], v6 offset:57568
    s_waitcnt lgkmcnt(13)
    v_add_f32 v64, v64, v10
    v_add_f32 v65, v65, v10
    v_add_f32 v66, v66, v11
    v_add_f32 v67, v67, v11
    ds_read_b64 v[94:95], v6 offset:57584
    s_waitcnt lgkmcnt(12)
    v_add_f32 v64, v64, v68
    v_add_f32 v65, v65, v69
    v_add_f32 v66, v66, v70
    v_add_f32 v67, v67, v71
    s_waitcnt lgkmcnt(10)
    v_add_f32 v64, v64, v72
    v_add_f32 v65, v65, v73
    v_add_f32 v66, v66, v74
    v_add_f32 v67, v67, v75
    s_waitcnt lgkmcnt(8)
    v_add_f32 v64, v64, v76
    v_add_f32 v65, v65, v77
    v_add_f32 v66, v66, v78
    v_add_f32 v67, v67, v79
    s_waitcnt lgkmcnt(6)
    v_add_f32 v64, v64, v80
    v_add_f32 v65, v65, v81
    v_add_f32 v66, v66, v82
    v_add_f32 v67, v67, v83
    s_waitcnt lgkmcnt(4)
    v_add_f32 v64, v64, v84
    v_add_f32 v65, v65, v85
    v_add_f32 v66, v66, v86
    v_add_f32 v67, v67, v87
    s_waitcnt lgkmcnt(2)
    v_add_f32 v64, v64, v88
    v_add_f32 v65, v65, v89
    v_add_f32 v66, v66, v90
    v_add_f32 v67, v67, v91
    s_waitcnt lgkmcnt(0)
    v_add_f32 v64, v64, v92
    v_add_f32 v65, v65, v93
    v_add_f32 v66, v66, v94
    v_add_f32 v67, v67, v95
    v_cvt_pk_bf16_f32 v68, v64, v66
    v_cvt_pk_bf16_f32 v69, v65, v67
    s_mov_b32 s34, 0x100000
    buffer_store_dword v68, v8, s[40:43], s34 offen
    buffer_store_dword v69, v8, s[40:43], s34 offen offset:1024
    s_endpgm
sequential_preLN__ssm_conv_s4__dense_activation_squared_relu__prompt_kernel_hr26:
    s_add_u32 s31, s31, 1
    s_cmp_gt_u32 s31, 30000
    s_cbranch_scc1 sequential_preLN__ssm_conv_s4__dense_activation_squared_relu__prompt_kernel_hr26b
    s_sleep 4
    buffer_load_dwordx4 v[216:219], v2, s[16:19], s6 offen offset:0 sc1
    buffer_load_dwordx4 v[220:223], v2, s[16:19], s6 offen offset:1024 sc1
    buffer_load_dwordx4 v[224:227], v2, s[16:19], s6 offen offset:2048 sc1
    buffer_load_dwordx4 v[228:231], v2, s[16:19], s6 offen offset:3072 sc1
    s_waitcnt vmcnt(0)
    v_xor_b32 v216, v216, v124
    v_xor_b32 v217, v217, v125
    v_xor_b32 v218, v218, v126
    v_xor_b32 v219, v219, v127
    v_or3_b32 v4, v216, v217, v218
    v_or_b32 v4, v4, v219
    v_xor_b32 v220, v220, v124
    v_xor_b32 v221, v221, v125
    v_xor_b32 v222, v222, v126
    v_xor_b32 v223, v223, v127
    v_or3_b32 v4, v220, v221, v4
    v_or3_b32 v4, v222, v223, v4
    v_xor_b32 v224, v224, v124
    v_xor_b32 v225, v225, v125
    v_xor_b32 v226, v226, v126
    v_xor_b32 v227, v227, v127
    v_or3_b32 v4, v224, v225, v4
    v_or3_b32 v4, v226, v227, v4
    v_xor_b32 v228, v228, v124
    v_xor_b32 v229, v229, v125
    v_xor_b32 v230, v230, v126
    v_xor_b32 v231, v231, v127
    v_or3_b32 v4, v228, v229, v4
    v_or3_b32 v4, v230, v231, v4
    v_and_b32 v4, s59, v4
    v_cmp_ne_u32 vcc, 0, v4
    s_cbranch_vccnz sequential_preLN__ssm_conv_s4__dense_activation_squared_relu__prompt_kernel_hr26
    s_branch sequential_preLN__ssm_conv_s4__dense_activation_squared_relu__prompt_kernel_hr26b
sequential_preLN__ssm_conv_s4__dense_activation_squared_relu__prompt_kernel_hr27:
    s_add_u32 s31, s31, 1
    s_cmp_gt_u32 s31, 30000
    s_cbranch_scc1 sequential_preLN__ssm_conv_s4__dense_activation_squared_relu__prompt_kernel_hr27b
    s_sleep 4
    buffer_load_dwordx4 v[232:235], v2, s[16:19], s7 offen offset:0 sc1
    buffer_load_dwordx4 v[236:239], v2, s[16:19], s7 offen offset:1024 sc1
    buffer_load_dwordx4 v[240:243], v2, s[16:19], s4 offen offset:0 sc1
    buffer_load_dwordx4 v[244:247], v2, s[16:19], s4 offen offset:1024 sc1
    s_waitcnt vmcnt(0)
    v_xor_b32 v232, v232, v124
    v_xor_b32 v233, v233, v125
    v_xor_b32 v234, v234, v126
    v_xor_b32 v235, v235, v127
    v_or3_b32 v4, v232, v233, v234
    v_or_b32 v4, v4, v235
    v_xor_b32 v236, v236, v124
    v_xor_b32 v237, v237, v125
    v_xor_b32 v238, v238, v126
    v_xor_b32 v239, v239, v127
    v_or3_b32 v4, v236, v237, v4
    v_or3_b32 v4, v238, v239, v4
    v_xor_b32 v240, v240, v124
    v_xor_b32 v241, v241, v125
    v_xor_b32 v242, v242, v126
    v_xor_b32 v243, v243, v127
    v_or3_b32 v4, v240, v241, v4
    v_or3_b32 v4, v242, v243, v4
    v_xor_b32 v244, v244, v124
    v_xor_b32 v245, v245, v125
    v_xor_b32 v246, v246, v126
    v_xor_b32 v247, v247, v127
    v_or3_b32 v4, v244, v245, v4
    v_or3_b32 v4, v246, v247, v4
    v_and_b32 v4, s59, v4
    v_cmp_ne_u32 vcc, 0, v4
    s_cbranch_vccnz sequential_preLN__ssm_conv_s4__dense_activation_squared_relu__prompt_kernel_hr27
    s_branch sequential_preLN__ssm_conv_s4__dense_activation_squared_relu__prompt_kernel_hr27b
sequential_preLN__ssm_conv_s4__dense_activation_squared_relu__prompt_kernel_hr28:
    s_add_u32 s31, s31, 1
    s_cmp_gt_u32 s31, 30000
    s_cbranch_scc1 sequential_preLN__ssm_conv_s4__dense_activation_squared_relu__prompt_kernel_hr28b
    s_sleep 4
    buffer_load_dwordx4 v[248:251], v2, s[16:19], s4 offen offset:2048 sc1
    buffer_load_dwordx4 v[252:255], v2, s[16:19], s4 offen offset:3072 sc1
    buffer_load_dwordx4 v[120:123], v2, s[16:19], s5 offen offset:0 sc1
    buffer_load_dwordx4 v[56:59], v2, s[16:19], s5 offen offset:1024 sc1
    s_waitcnt vmcnt(0)
    v_xor_b32 v248, v248, v124
    v_xor_b32 v249, v249, v125
    v_xor_b32 v250, v250, v126
    v_xor_b32 v251, v251, v127
    v_or3_b32 v4, v248, v249, v250
    v_or_b32 v4, v4, v251
    v_xor_b32 v252, v252, v124
    v_xor_b32 v253, v253, v125
    v_xor_b32 v254, v254, v126
    v_xor_b32 v255, v255, v127
    v_or3_b32 v4, v252, v253, v4
    v_or3_b32 v4, v254, v255, v4
    v_xor_b32 v120, v120, v124
    v_xor_b32 v121, v121, v125
    v_xor_b32 v122, v122, v126
    v_xor_b32 v123, v123, v127
    v_or3_b32 v4, v120, v121, v4
    v_or3_b32 v4, v122, v123, v4
    v_xor_b32 v56, v56, v124
    v_xor_b32 v57, v57, v125
    v_xor_b32 v58, v58, v126
    v_xor_b32 v59, v59, v127
    v_or3_b32 v4, v56, v57, v4
    v_or3_b32 v4, v58, v59, v4
    v_and_b32 v4, s59, v4
    v_cmp_ne_u32 vcc, 0, v4
    s_cbranch_vccnz sequential_preLN__ssm_conv_s4__dense_activation_squared_relu__prompt_kernel_hr28
    s_branch sequential_preLN__ssm_conv_s4__dense_activation_squared_relu__prompt_kernel_hr28b
sequential_preLN__ssm_conv_s4__dense_activation_squared_relu__prompt_kernel_hr29:
    s_add_u32 s31, s31, 1
    s_cmp_gt_u32 s31, 30000
    s_cbranch_scc1 sequential_preLN__ssm_conv_s4__dense_activation_squared_relu__prompt_kernel_hr29b
    s_sleep 4
    buffer_load_dwordx4 v[60:63], v2, s[16:19], s5 offen offset:2048 sc1
    buffer_load_dwordx4 v[48:51], v2, s[16:19], s5 offen offset:3072 sc1
    buffer_load_dwordx4 v[216:219], v2, s[20:23], s6 offen offset:0 sc1
    buffer_load_dwordx4 v[220:223], v2, s[20:23], s6 offen offset:1024 sc1
    s_waitcnt vmcnt(0)
    v_xor_b32 v60, v60, v124
    v_xor_b32 v61, v61, v125
    v_xor_b32 v62, v62, v126
    v_xor_b32 v63, v63, v127
    v_or3_b32 v4, v60, v61, v62
    v_or_b32 v4, v4, v63
    v_xor_b32 v48, v48, v124
    v_xor_b32 v49, v49, v125
    v_xor_b32 v50, v50, v126
    v_xor_b32 v51, v51, v127
    v_or3_b32 v4, v48, v49, v4
    v_or3_b32 v4, v50, v51, v4
    v_xor_b32 v216, v216, v124
    v_xor_b32 v217, v217, v125
    v_xor_b32 v218, v218, v126
    v_xor_b32 v219, v219, v127
    v_or3_b32 v4, v216, v217, v4
    v_or3_b32 v4, v218, v219, v4
    v_xor_b32 v220, v220, v124
    v_xor_b32 v221, v221, v125
    v_xor_b32 v222, v222, v126
    v_xor_b32 v223, v223, v127
    v_or3_b32 v4, v220, v221, v4
    v_or3_b32 v4, v222, v223, v4
    v_and_b32 v4, s59, v4
    v_cmp_ne_u32 vcc, 0, v4
    s_cbranch_vccnz sequential_preLN__ssm_conv_s4__dense_activation_squared_relu__prompt_kernel_hr29
    s_branch sequential_preLN__ssm_conv_s4__dense_activation_squared_relu__prompt_kernel_hr29b
sequential_preLN__ssm_conv_s4__dense_activation_squared_relu__prompt_kernel_hr30:
    s_add_u32 s31, s31, 1
    s_cmp_gt_u32 s31, 30000
    s_cbranch_scc1 sequential_preLN__ssm_conv_s4__dense_activation_squared_relu__prompt_kernel_hr30b
    s_sleep 4
    buffer_load_dwordx4 v[224:227], v2, s[20:23], s6 offen offset:2048 sc1
    buffer_load_dwordx4 v[228:231], v2, s[20:23], s6 offen offset:3072 sc1
    buffer_load_dwordx4 v[232:235], v2, s[20:23], s7 offen offset:0 sc1
    buffer_load_dwordx4 v[236:239], v2, s[20:23], s7 offen offset:1024 sc1
    s_waitcnt vmcnt(0)
    v_xor_b32 v224, v224, v124
    v_xor_b32 v225, v225, v125
    v_xor_b32 v226, v226, v126
    v_xor_b32 v227, v227, v127
    v_or3_b32 v4, v224, v225, v226
    v_or_b32 v4, v4, v227
    v_xor_b32 v228, v228, v124
    v_xor_b32 v229, v229, v125
    v_xor_b32 v230, v230, v126
    v_xor_b32 v231, v231, v127
    v_or3_b32 v4, v228, v229, v4
    v_or3_b32 v4, v230, v231, v4
    v_xor_b32 v232, v232, v124
    v_xor_b32 v233, v233, v125
    v_xor_b32 v234, v234, v126
    v_xor_b32 v235, v235, v127
    v_or3_b32 v4, v232, v233, v4
    v_or3_b32 v4, v234, v235, v4
    v_xor_b32 v236, v236, v124
    v_xor_b32 v237, v237, v125
    v_xor_b32 v238, v238, v126
    v_xor_b32 v239, v239, v127
    v_or3_b32 v4, v236, v237, v4
    v_or3_b32 v4, v238, v239, v4
    v_and_b32 v4, s59, v4
    v_cmp_ne_u32 vcc, 0, v4
    s_cbranch_vccnz sequential_preLN__ssm_conv_s4__dense_activation_squared_relu__prompt_kernel_hr30
    s_branch sequential_preLN__ssm_conv_s4__dense_activation_squared_relu__prompt_kernel_hr30b
sequential_preLN__ssm_conv_s4__dense_activation_squared_relu__prompt_kernel_hr31:
    s_add_u32 s31, s31, 1
    s_cmp_gt_u32 s31, 30000
    s_cbranch_scc1 sequential_preLN__ssm_conv_s4__dense_activation_squared_relu__prompt_kernel_hr31b
    s_sleep 4
    buffer_load_dwordx4 v[240:243], v2, s[20:23], s4 offen offset:0 sc1
    buffer_load_dwordx4 v[244:247], v2, s[20:23], s4 offen offset:1024 sc1
    buffer_load_dwordx4 v[248:251], v2, s[20:23], s4 offen offset:2048 sc1
    buffer_load_dwordx4 v[252:255], v2, s[20:23], s4 offen offset:3072 sc1
    s_waitcnt vmcnt(0)
    v_xor_b32 v240, v240, v124
    v_xor_b32 v241, v241, v125
    v_xor_b32 v242, v242, v126
    v_xor_b32 v243, v243, v127
    v_or3_b32 v4, v240, v241, v242
    v_or_b32 v4, v4, v243
    v_xor_b32 v244, v244, v124
    v_xor_b32 v245, v245, v125
    v_xor_b32 v246, v246, v126
    v_xor_b32 v247, v247, v127
    v_or3_b32 v4, v244, v245, v4
    v_or3_b32 v4, v246, v247, v4
    v_xor_b32 v248, v248, v124
    v_xor_b32 v249, v249, v125
    v_xor_b32 v250, v250, v126
    v_xor_b32 v251, v251, v127
    v_or3_b32 v4, v248, v249, v4
    v_or3_b32 v4, v250, v251, v4
    v_xor_b32 v252, v252, v124
    v_xor_b32 v253, v253, v125
    v_xor_b32 v254, v254, v126
    v_xor_b32 v255, v255, v127
    v_or3_b32 v4, v252, v253, v4
    v_or3_b32 v4, v254, v255, v4
    v_and_b32 v4, s59, v4
    v_cmp_ne_u32 vcc, 0, v4
    s_cbranch_vccnz sequential_preLN__ssm_conv_s4__dense_activation_squared_relu__prompt_kernel_hr31
    s_branch sequential_preLN__ssm_conv_s4__dense_activation_squared_relu__prompt_kernel_hr31b
sequential_preLN__ssm_conv_s4__dense_activation_squared_relu__prompt_kernel_hr32:
    s_add_u32 s31, s31, 1
    s_cmp_gt_u32 s31, 30000
    s_cbranch_scc1 sequential_preLN__ssm_conv_s4__dense_activation_squared_relu__prompt_kernel_hr32b
    s_sleep 4
    buffer_load_dwordx4 v[120:123], v2, s[20:23], s5 offen offset:0 sc1
    buffer_load_dwordx4 v[56:59], v2, s[20:23], s5 offen offset:1024 sc1
    buffer_load_dwordx4 v[60:63], v2, s[20:23], s5 offen offset:2048 sc1
    buffer_load_dwordx4 v[48:51], v2, s[20:23], s5 offen offset:3072 sc1
    s_waitcnt vmcnt(0)
    v_xor_b32 v120, v120, v124
    v_xor_b32 v121, v121, v125
    v_xor_b32 v122, v122, v126
    v_xor_b32 v123, v123, v127
    v_or3_b32 v4, v120, v121, v122
    v_or_b32 v4, v4, v123
    v_xor_b32 v56, v56, v124
    v_xor_b32 v57, v57, v125
    v_xor_b32 v58, v58, v126
    v_xor_b32 v59, v59, v127
    v_or3_b32 v4, v56, v57, v4
    v_or3_b32 v4, v58, v59, v4
    v_xor_b32 v60, v60, v124
    v_xor_b32 v61, v61, v125
    v_xor_b32 v62, v62, v126
    v_xor_b32 v63, v63, v127
    v_or3_b32 v4, v60, v61, v4
    v_or3_b32 v4, v62, v63, v4
    v_xor_b32 v48, v48, v124
    v_xor_b32 v49, v49, v125
    v_xor_b32 v50, v50, v126
    v_xor_b32 v51, v51, v127
    v_or3_b32 v4, v48, v49, v4
    v_or3_b32 v4, v50, v51, v4
    v_and_b32 v4, s59, v4
    v_cmp_ne_u32 vcc, 0, v4
    s_cbranch_vccnz sequential_preLN__ssm_conv_s4__dense_activation_squared_relu__prompt_kernel_hr32
    s_branch sequential_preLN__ssm_conv_s4__dense_activation_squared_relu__prompt_kernel_hr32b
sequential_preLN__ssm_conv_s4__dense_activation_squared_relu__prompt_kernel_done1:
    s_endpgm
.section .rodata,"a"
.p2align 6
.amdhsa_kernel sequential_preLN__ssm_conv_s4__dense_activation_squared_relu__prompt_kernel
  .amdhsa_next_free_vgpr 256
  .amdhsa_next_free_sgpr 102
  .amdhsa_accum_offset 256
  .amdhsa_group_segment_fixed_size 0
  .amdhsa_kernarg_size 136
  .amdhsa_user_sgpr_count 2
  .amdhsa_user_sgpr_kernarg_segment_ptr 1
  .amdhsa_system_sgpr_workgroup_id_x 1
.end_amdhsa_kernel
```
